```python
import torch

def _softmax(x, axis=-1):
    return torch.softmax(x, dim=axis)

def _gelu(x):
    return torch.nn.functional.gelu(x, approximate='tanh')

def _silu(x):
    return torch.nn.functional.silu(x)

def _sigmoid(x):
    return torch.sigmoid(x)

def _layernorm(x, axis=-1, eps=1e-05):
    m = x.mean(dim=axis, keepdim=True)
    v = x.var(dim=axis, keepdim=True, unbiased=False)
    return (x - m) / torch.sqrt(v + eps)

def _scatter_add(tgt, idx, src, axis=0):
    return tgt.clone().index_add_(axis, idx, src)

def _segment_sum(src, seg, n):
    out = torch.zeros((n,) + src.shape[1:], dtype=src.dtype)
    return out.index_add_(0, seg, src)

def _pad(x, pw):
    flat = tuple((v for pair in reversed(pw) for v in pair))
    return torch.nn.functional.pad(x, flat)
kernel_name = 'concat_heads__memory_aug_recurrent_mem_tr__ssm_conv_s4__prompt'

def setup_inputs():

    _w = lambda a: (lambda t: t.to(torch.bfloat16) if t.is_floating_point() else t)(torch.as_tensor(a))

    def _A_setup():
        B, S, Dm = (1, 2048, 576)
        H, Dh = (32, 128)
        M, seg = (8, 32)
        seg = min(seg, S)
        S = S // seg * seg
        return {'x': _w((lambda *s: torch.randn(*s, dtype=torch.bfloat16) * 0.05)(B, S, Dm)), 'mem0': _w((lambda *s: torch.randn(*s, dtype=torch.bfloat16) * 0.4)(B, M, Dm)), 'Wq': _w((lambda *s: torch.randn(*s, dtype=torch.bfloat16) * 6.4)(Dm, H, Dh) * Dm ** (-0.5)), 'Wk': _w((lambda *s: torch.randn(*s, dtype=torch.bfloat16) * 6.4)(Dm, H, Dh) * Dm ** (-0.5)), 'Wv': _w((lambda *s: torch.randn(*s, dtype=torch.bfloat16) * 0.4)(Dm, H, Dh) * Dm ** (-0.5)), 'Wo': _w((lambda *s: torch.randn(*s, dtype=torch.bfloat16) * 0.4)(H, Dh, Dm) * (H * Dh) ** (-0.5)), 'seg_len': seg}
    _A_in = _A_setup()

    def _B_setup():
        B, L, D, N = (1, 2048, 576, 128)
        A_re = -(lambda _x: torch.exp(torch.as_tensor(_x)))((lambda *s: torch.randn(*s, dtype=torch.bfloat16) * 3.2)(D, N))
        A_im = torch.pi * (lambda *s: torch.randn(*s, dtype=torch.bfloat16) * 0.05)(D, N)
        B_re = (lambda *s: torch.randn(*s, dtype=torch.bfloat16) * 0.2)(D, N)
        B_im = (lambda *s: torch.randn(*s, dtype=torch.bfloat16) * 0.1)(D, N)
        C_re = (lambda *s: torch.randn(*s, dtype=torch.bfloat16) * 0.2)(D, N)
        C_im = (lambda *s: torch.randn(*s, dtype=torch.bfloat16) * 0.2)(D, N)
        log_dt = (lambda *s: torch.randn(*s, dtype=torch.bfloat16) * 0.05)(D) * 0.5 - 4.0
        Dskip = (lambda *s: torch.randn(*s, dtype=torch.bfloat16) * 0.05)(D)
        return {'u': _w((lambda *s: torch.randn(*s, dtype=torch.bfloat16) * 0.05)(B, L, D)), 'A_re': _w(A_re), 'A_im': _w(A_im), 'B_re': _w(B_re), 'B_im': _w(B_im), 'C_re': _w(C_re), 'C_im': _w(C_im), 'log_dt': _w(log_dt), 'Dskip': _w(Dskip)}
    _B_in = _B_setup()
    return {'A_x': _A_in['x'], 'A_mem0': _A_in['mem0'], 'A_Wq': _A_in['Wq'], 'A_Wk': _A_in['Wk'], 'A_Wv': _A_in['Wv'], 'A_Wo': _A_in['Wo'], 'A_seg_len': _A_in['seg_len'], 'B_u': _B_in['u'], 'B_A_re': _B_in['A_re'], 'B_A_im': _B_in['A_im'], 'B_B_re': _B_in['B_re'], 'B_B_im': _B_in['B_im'], 'B_C_re': _B_in['C_re'], 'B_C_im': _B_in['C_im'], 'B_log_dt': _B_in['log_dt'], 'B_Dskip': _B_in['Dskip']}

def reference(A_x, A_mem0, A_Wq, A_Wk, A_Wv, A_Wo, A_seg_len, B_u, B_A_re, B_A_im, B_B_re, B_B_im, B_C_re, B_C_im, B_log_dt, B_Dskip):

    def _A_ref(x, mem0, Wq, Wk, Wv, Wo, seg_len):
        B, S, Dm = x.shape
        H, Dh = (Wq.shape[1], Wq.shape[2])
        M = mem0.shape[1]
        scale = Dh ** (-0.5)
        n_seg = S // seg_len
        L = M + seg_len
        idx = torch.arange(L)
        mask = (idx[:, None] < M) | (idx[:, None] >= idx[None, :])
        mem = mem0
        outs = []
        for s in range(n_seg):
            xs = x[:, s * seg_len:(s + 1) * seg_len, :].clone()
            h = torch.concatenate([mem, xs], axis=1)
            q = torch.einsum('btd,dhe->bhte', h, Wq)
            k = torch.einsum('btd,dhe->bhte', h, Wk)
            v = torch.einsum('btd,dhe->bhte', h, Wv)
            scores = torch.einsum('bhqe,bhke->bhqk', q, k) * scale
            scores = torch.where(mask[None, None], scores, -1000000000.0)
            p = _softmax(scores, axis=-1)
            o = torch.einsum('bhqk,bhke->bhqe', p, v)
            o = torch.einsum('bhte,hed->btd', o, Wo)
            mem = o[:, :M, :].clone()
            outs.append(o[:, M:, :])
        return torch.concatenate(outs, axis=1)

    def _B_ref(u, A_re, A_im, B_re, B_im, C_re, C_im, log_dt, Dskip):
        Bsz, L, D = u.shape
        dt = torch.exp(log_dt)[:, None]
        A = A_re + 1j * A_im
        Bc = B_re + 1j * B_im
        Cc = C_re + 1j * C_im
        logdA = dt * A
        dB = dt * Bc
        l = (lambda x, dt: x.to(dt))(torch.arange(L), A_re.dtype)
        P = torch.exp(logdA[:, :, None] * l[None, None, :])
        K = torch.einsum('dn,dnl,dn->dl', Cc, P, dB).real
        L2 = 2 * L
        Kp = _pad(K, ((0, 0), (0, L)))
        up = (lambda x, *d: x.permute(*d))(u, 0, 2, 1)
        up = _pad(up, ((0, 0), (0, 0), (0, L)))
        Kf = (lambda x, axes=(-2, -1): torch.fft.rfft2(x.float(), dim=axes))(Kp[:, None, :], axes=(-2, -1))
        Uf = (lambda x, axes=(-2, -1): torch.fft.rfft2(x.float(), dim=axes))(up[:, :, None, :], axes=(-2, -1))
        Yf = Uf * Kf[None, :, :, :]
        y = (lambda x, s, axes=(-2, -1): torch.fft.irfft2(x, s=s, dim=axes).to(torch.bfloat16))(Yf, (1, L2), axes=(-2, -1))[:, :, 0, :L]
        y = (lambda x, *d: x.permute(*d))(y, 0, 2, 1) + u * Dskip[None, None, :]
        return y
    a = _A_ref(A_x, A_mem0, A_Wq, A_Wk, A_Wv, A_Wo, A_seg_len)
    b = _B_ref(B_u, B_A_re, B_A_im, B_B_re, B_B_im, B_C_re, B_C_im, B_log_dt, B_Dskip)
    return torch.concatenate([a, b], axis=-1)
```

```asm
; @launch kernel=main_kernel grid=(256,1,1) block=(256,1,1) lds=163840
.amdgcn_target "amdgcn-amd-amdhsa--gfx950"
.text
.globl main_kernel
.p2align 8
.type main_kernel,@function
main_kernel:
    s_cmp_ge_u32 s2, 256
    s_cbranch_scc1 M_EXIT
    v_accvgpr_write_b32 a255, v0
    s_mov_b32 s98, 0
    s_load_dwordx2 s[4:5], s[0:1], 136
    s_getreg_b32 s6, hwreg(HW_REG_XCC_ID, 0, 4)
    s_and_b32 s6, s6, 7
    s_waitcnt lgkmcnt(0)
    s_mov_b32 s8, s4
    s_mov_b32 s9, s5
    s_mov_b32 s10, 256
    s_mov_b32 s11, 0x00020000
    v_lshrrev_b32 v1, 6, v0
    s_nop 0
    v_readfirstlane_b32 s7, v1
    s_cmp_lg_u32 s7, 0
    s_cbranch_scc1 EJ_2
    s_lshl_b32 s12, s6, 2
    v_mov_b32 v2, s12
    v_mov_b32 v3, 1
    s_mov_b64 exec, 1
    buffer_atomic_add v3, v2, s[8:11], 0 offen sc0
    s_waitcnt vmcnt(0)
    v_readfirstlane_b32 s13, v3
    s_mov_b32 s14, 0
    s_cmp_ge_u32 s13, 32
    s_cbranch_scc1 EW_1
    s_cmp_lg_u32 s13, 31
    s_cbranch_scc1 EQ_4
    s_add_u32 s15, s6, 1
    v_mov_b32 v4, s15
    v_mov_b32 v5, 0
    v_mov_b32 v2, 32
    buffer_atomic_cmpswap v[4:5], v2, s[8:11], 0 offen sc0
    s_waitcnt vmcnt(0)
EQ_4:
    s_mov_b32 s16, 200000
    v_mov_b32 v2, 32
EP_3:
    buffer_load_dword v3, v2, s[8:11], 0 offen sc1
    s_waitcnt vmcnt(0)
    v_readfirstlane_b32 s15, v3
    s_cmp_lg_u32 s15, 0
    s_cbranch_scc1 ER_5
    s_sub_u32 s16, s16, 1
    s_cmp_gt_i32 s16, 0
    s_cbranch_scc1 EP_3
ER_5:
    s_add_u32 s16, s6, 1
    s_cmp_eq_u32 s15, s16
    s_cselect_b32 s14, 1, 0
EW_1:
    s_mov_b64 exec, -1
    s_lshl_b32 s14, s14, 8
    s_or_b32 s14, s14, s13
    v_mov_b32 v2, 0
    v_mov_b32 v3, s14
    ds_write_b32 v2, v3
    s_waitcnt lgkmcnt(0)
EJ_2:
    s_barrier
    v_mov_b32 v2, 0
    ds_read_b32 v3, v2
    s_waitcnt lgkmcnt(0)
    v_readfirstlane_b32 s14, v3
    s_barrier
    s_and_b32 s70, s14, 255
    s_lshr_b32 s14, s14, 8
    s_cmp_eq_u32 s14, 1
    s_cbranch_scc1 M_CHAIN
    s_branch M_WORK
M_CHAIN:
    v_lshrrev_b32 v1, 6, v0
    v_and_b32 v0, 63, v0
    s_nop 0
    v_readfirstlane_b32 s20, v1
    s_load_dwordx4 s[60:63], s[0:1], 16
    s_load_dwordx4 s[64:67], s[0:1], 32
    s_load_dwordx2 s[68:69], s[0:1], 8
    s_load_dwordx4 s[72:75], s[0:1], 136
    s_waitcnt lgkmcnt(0)
    s_mov_b32 s8, s60
    s_mov_b32 s9, s61
    s_mov_b32 s10, 4718592
    s_mov_b32 s11, 0x00020000
    s_mov_b32 s12, s62
    s_mov_b32 s13, s63
    s_mov_b32 s14, 4718592
    s_mov_b32 s15, 0x00020000
    s_mov_b32 s16, s64
    s_mov_b32 s17, s65
    s_mov_b32 s18, 4718592
    s_mov_b32 s19, 0x00020000
    s_mov_b32 s24, s66
    s_mov_b32 s25, s67
    s_mov_b32 s26, 4718592
    s_mov_b32 s27, 0x00020000
    s_add_u32 s28, s74, 83886080
    s_addc_u32 s29, s75, 0
    s_mov_b32 s30, 2097152
    s_mov_b32 s31, 0x00020000
    s_add_u32 s32, s74, 16777216
    s_addc_u32 s33, s75, 0
    s_mov_b32 s34, 16777216
    s_mov_b32 s35, 0x00020000
    s_add_u32 s36, s74, 33554432
    s_addc_u32 s37, s75, 0
    s_mov_b32 s38, 16777216
    s_mov_b32 s39, 0x00020000
    s_add_u32 s48, s74, 67108864
    s_addc_u32 s49, s75, 0
    s_mov_b32 s50, 16777216
    s_mov_b32 s51, 0x00020000
    s_mov_b32 s52, s68
    s_mov_b32 s53, s69
    s_mov_b32 s54, 9216
    s_mov_b32 s55, 0x00020000
    s_mov_b32 s56, s72
    s_mov_b32 s57, s73
    s_mov_b32 s58, 256
    s_mov_b32 s59, 0x00020000
    v_lshlrev_b32 v1, 4, v0
    v_mov_b32 v16, -1
    v_mov_b32 v17, -1
    v_mov_b32 v18, -1
    v_mov_b32 v19, -1
    s_cmp_lg_u32 s20, 0
    s_cbranch_scc1 CZ_6
    s_add_u32 s40, s74, 92274688
    s_addc_u32 s41, s75, 0
    s_mov_b32 s42, 20480
    s_mov_b32 s43, 0x00020000
    s_mul_i32 s21, s70, 640
    v_mov_b32 v24, 0
    v_mov_b32 v25, 0
    v_mov_b32 v26, 0
    v_mov_b32 v27, 0
    s_mov_b32 exec_hi, 0xff
    buffer_store_dwordx4 v[24:27], v1, s[40:43], s21 offen sc1
    s_mov_b64 exec, -1
CZ_6:
    s_mul_i32 s21, s70, 9216
    s_lshl_b32 s22, s20, 10
    s_add_u32 s21, s21, s22
    v_add_u32 v20, s21, v1
    s_mov_b32 s22, 0
    buffer_store_dwordx4 v[16:19], v20, s[28:31], s22 offen
    s_mov_b32 s22, 4096
    buffer_store_dwordx4 v[16:19], v20, s[28:31], s22 offen
    s_mov_b32 s22, 294912
    buffer_store_dwordx4 v[16:19], v20, s[28:31], s22 offen
    s_mov_b32 s22, 299008
    buffer_store_dwordx4 v[16:19], v20, s[28:31], s22 offen
    s_cmp_lg_u32 s20, 0
    s_cbranch_scc1 CI_7
    s_mov_b32 s22, 8192
    buffer_store_dwordx4 v[16:19], v20, s[28:31], s22 offen
    s_mov_b32 s22, 303104
    buffer_store_dwordx4 v[16:19], v20, s[28:31], s22 offen
    s_cmp_ge_u32 s70, 9
    s_cbranch_scc1 CI_7
    s_lshl_b32 s22, s70, 10
    s_add_u32 s22, s22, 1048576
    buffer_store_dwordx4 v[16:19], v1, s[28:31], s22 offen
    s_add_u32 s22, s22, 16384
    buffer_store_dwordx4 v[16:19], v1, s[28:31], s22 offen
CI_7:
    s_waitcnt vmcnt(0)
    s_barrier
    s_cmp_lg_u32 s20, 0
    s_cbranch_scc1 CA_8
    v_mov_b32 v16, 1
    v_mov_b32 v17, 64
    s_mov_b64 exec, 1
    buffer_atomic_add v16, v17, s[56:59], 0 offen
    s_mov_b64 exec, -1
CA_8:
    v_bfe_u32 v16, v0, 4, 1
    v_lshlrev_b32 v16, 4, v16
    v_bfe_u32 v17, v0, 3, 1
    v_lshl_add_u32 v16, v17, 2, v16
    v_bfe_u32 v17, v0, 1, 1
    v_add_u32 v16, v16, v17
    v_bfe_u32 v17, v0, 2, 1
    v_lshl_add_u32 v16, v17, 3, v16
    v_bfe_u32 v17, v0, 5, 1
    v_lshlrev_b32 v17, 5, v17
    v_and_b32 v18, 1, v0
    v_lshl_add_u32 v17, v18, 4, v17
    v_lshl_add_u32 v21, v16, 13, v17
    s_lshl_b32 s21, s70, 8
    s_lshl_b32 s22, s20, 6
    s_add_u32 s21, s21, s22
    v_add_u32 v21, s21, v21
    v_mul_u32_u24 v22, 1152, v16
    v_add_u32 v22, v22, v17
    s_mul_i32 s21, s70, 147456
    s_mul_i32 s22, s20, 288
    s_add_u32 s21, s21, s22
    v_add_u32 v22, s21, v22
    s_mul_i32 s23, s20, 34816
    s_lshl_b32 s40, s20, 12
    s_add_u32 s40, s40, 139264
    v_lshlrev_b32 v23, 3, v0
    v_add_u32 v24, s40, v23
    v_add_u32 v23, s23, v23
    v_add_u32 v10, s23, v1
    s_add_u32 m0, s23, 0
    s_mov_b32 s21, 0
    buffer_load_dwordx4 v21, s[8:11], s21 offen lds
    s_add_u32 m0, s23, 1024
    s_mov_b32 s21, 16384
    buffer_load_dwordx4 v21, s[8:11], s21 offen lds
    s_add_u32 m0, s23, 2048
    s_mov_b32 s21, 262144
    buffer_load_dwordx4 v21, s[8:11], s21 offen lds
    s_add_u32 m0, s23, 3072
    s_mov_b32 s21, 278528
    buffer_load_dwordx4 v21, s[8:11], s21 offen lds
    s_add_u32 m0, s23, 4096
    s_mov_b32 s21, 524288
    buffer_load_dwordx4 v21, s[8:11], s21 offen lds
    s_add_u32 m0, s23, 5120
    s_mov_b32 s21, 540672
    buffer_load_dwordx4 v21, s[8:11], s21 offen lds
    s_add_u32 m0, s23, 6144
    s_mov_b32 s21, 786432
    buffer_load_dwordx4 v21, s[8:11], s21 offen lds
    s_add_u32 m0, s23, 7168
    s_mov_b32 s21, 802816
    buffer_load_dwordx4 v21, s[8:11], s21 offen lds
    s_add_u32 m0, s23, 8192
    s_mov_b32 s21, 1572864
    buffer_load_dwordx4 v21, s[8:11], s21 offen lds
    s_add_u32 m0, s23, 9216
    s_mov_b32 s21, 1589248
    buffer_load_dwordx4 v21, s[8:11], s21 offen lds
    s_add_u32 m0, s23, 10240
    s_mov_b32 s21, 1835008
    buffer_load_dwordx4 v21, s[8:11], s21 offen lds
    s_add_u32 m0, s23, 11264
    s_mov_b32 s21, 1851392
    buffer_load_dwordx4 v21, s[8:11], s21 offen lds
    s_add_u32 m0, s23, 12288
    s_mov_b32 s21, 2097152
    buffer_load_dwordx4 v21, s[8:11], s21 offen lds
    s_add_u32 m0, s23, 13312
    s_mov_b32 s21, 2113536
    buffer_load_dwordx4 v21, s[8:11], s21 offen lds
    s_add_u32 m0, s23, 14336
    s_mov_b32 s21, 2359296
    buffer_load_dwordx4 v21, s[8:11], s21 offen lds
    s_add_u32 m0, s23, 15360
    s_mov_b32 s21, 2375680
    buffer_load_dwordx4 v21, s[8:11], s21 offen lds
    s_add_u32 m0, s23, 16384
    s_mov_b32 s21, 2621440
    buffer_load_dwordx4 v21, s[8:11], s21 offen lds
    s_add_u32 m0, s23, 17408
    s_mov_b32 s21, 2637824
    buffer_load_dwordx4 v21, s[8:11], s21 offen lds
    s_add_u32 m0, s23, 18432
    s_mov_b32 s21, 2883584
    buffer_load_dwordx4 v21, s[8:11], s21 offen lds
    s_add_u32 m0, s23, 19456
    s_mov_b32 s21, 2899968
    buffer_load_dwordx4 v21, s[8:11], s21 offen lds
    s_add_u32 m0, s23, 20480
    s_mov_b32 s21, 3670016
    buffer_load_dwordx4 v21, s[8:11], s21 offen lds
    s_add_u32 m0, s23, 21504
    s_mov_b32 s21, 3686400
    buffer_load_dwordx4 v21, s[8:11], s21 offen lds
    s_add_u32 m0, s23, 22528
    s_mov_b32 s21, 3932160
    buffer_load_dwordx4 v21, s[8:11], s21 offen lds
    s_add_u32 m0, s23, 23552
    s_mov_b32 s21, 3948544
    buffer_load_dwordx4 v21, s[8:11], s21 offen lds
    s_add_u32 m0, s23, 24576
    s_mov_b32 s21, 4194304
    buffer_load_dwordx4 v21, s[8:11], s21 offen lds
    s_add_u32 m0, s23, 25600
    s_mov_b32 s21, 4210688
    buffer_load_dwordx4 v21, s[8:11], s21 offen lds
    s_add_u32 m0, s23, 26624
    s_mov_b32 s21, 4456448
    buffer_load_dwordx4 v21, s[8:11], s21 offen lds
    s_add_u32 m0, s23, 27648
    s_mov_b32 s21, 4472832
    buffer_load_dwordx4 v21, s[8:11], s21 offen lds
    s_add_u32 m0, s23, 28672
    s_mov_b32 s21, 0
    buffer_load_dwordx4 v21, s[12:15], s21 offen lds
    s_add_u32 m0, s23, 29696
    s_mov_b32 s21, 16384
    buffer_load_dwordx4 v21, s[12:15], s21 offen lds
    s_add_u32 m0, s23, 30720
    s_mov_b32 s21, 262144
    buffer_load_dwordx4 v21, s[12:15], s21 offen lds
    s_add_u32 m0, s23, 31744
    s_mov_b32 s21, 278528
    buffer_load_dwordx4 v21, s[12:15], s21 offen lds
    s_waitcnt vmcnt(28)
    ds_read_b64_tr_b16 a[0:1], v23 offset:0
    ds_read_b64_tr_b16 a[2:3], v23 offset:1024
    ds_read_b64_tr_b16 a[4:5], v23 offset:2048
    ds_read_b64_tr_b16 a[6:7], v23 offset:3072
    ds_read_b64_tr_b16 a[8:9], v23 offset:512
    ds_read_b64_tr_b16 a[10:11], v23 offset:1536
    ds_read_b64_tr_b16 a[12:13], v23 offset:2560
    ds_read_b64_tr_b16 a[14:15], v23 offset:3584
    s_waitcnt lgkmcnt(0)
    s_add_u32 m0, s23, 0
    s_mov_b32 s21, 524288
    buffer_load_dwordx4 v21, s[12:15], s21 offen lds
    s_add_u32 m0, s23, 1024
    s_mov_b32 s21, 540672
    buffer_load_dwordx4 v21, s[12:15], s21 offen lds
    s_add_u32 m0, s23, 2048
    s_mov_b32 s21, 786432
    buffer_load_dwordx4 v21, s[12:15], s21 offen lds
    s_add_u32 m0, s23, 3072
    s_mov_b32 s21, 802816
    buffer_load_dwordx4 v21, s[12:15], s21 offen lds
    s_add_u32 m0, s40, 0
    s_mov_b32 s21, 73984
    buffer_load_dwordx4 v22, s[24:27], s21 offen lds
    s_add_u32 m0, s40, 1024
    s_mov_b32 s21, 76288
    buffer_load_dwordx4 v22, s[24:27], s21 offen lds
    s_add_u32 m0, s40, 2048
    s_mov_b32 s21, 110848
    buffer_load_dwordx4 v22, s[24:27], s21 offen lds
    s_add_u32 m0, s40, 3072
    s_mov_b32 s21, 113152
    buffer_load_dwordx4 v22, s[24:27], s21 offen lds
    s_waitcnt vmcnt(32)
    ds_read_b64_tr_b16 a[16:17], v23 offset:4096
    ds_read_b64_tr_b16 a[18:19], v23 offset:5120
    ds_read_b64_tr_b16 a[20:21], v23 offset:6144
    ds_read_b64_tr_b16 a[22:23], v23 offset:7168
    ds_read_b64_tr_b16 a[24:25], v23 offset:4608
    ds_read_b64_tr_b16 a[26:27], v23 offset:5632
    ds_read_b64_tr_b16 a[28:29], v23 offset:6656
    ds_read_b64_tr_b16 a[30:31], v23 offset:7680
    s_waitcnt lgkmcnt(0)
    s_add_u32 m0, s23, 4096
    s_mov_b32 s21, 1048576
    buffer_load_dwordx4 v21, s[12:15], s21 offen lds
    s_add_u32 m0, s23, 5120
    s_mov_b32 s21, 1064960
    buffer_load_dwordx4 v21, s[12:15], s21 offen lds
    s_add_u32 m0, s23, 6144
    s_mov_b32 s21, 1310720
    buffer_load_dwordx4 v21, s[12:15], s21 offen lds
    s_add_u32 m0, s23, 7168
    s_mov_b32 s21, 1327104
    buffer_load_dwordx4 v21, s[12:15], s21 offen lds
    s_waitcnt vmcnt(32)
    ds_read_b64_tr_b16 a[32:33], v23 offset:8192
    ds_read_b64_tr_b16 a[34:35], v23 offset:9216
    ds_read_b64_tr_b16 a[36:37], v23 offset:10240
    ds_read_b64_tr_b16 a[38:39], v23 offset:11264
    ds_read_b64_tr_b16 a[40:41], v23 offset:8704
    ds_read_b64_tr_b16 a[42:43], v23 offset:9728
    ds_read_b64_tr_b16 a[44:45], v23 offset:10752
    ds_read_b64_tr_b16 a[46:47], v23 offset:11776
    s_waitcnt lgkmcnt(0)
    s_add_u32 m0, s23, 8192
    s_mov_b32 s21, 1572864
    buffer_load_dwordx4 v21, s[12:15], s21 offen lds
    s_add_u32 m0, s23, 9216
    s_mov_b32 s21, 1589248
    buffer_load_dwordx4 v21, s[12:15], s21 offen lds
    s_add_u32 m0, s23, 10240
    s_mov_b32 s21, 1835008
    buffer_load_dwordx4 v21, s[12:15], s21 offen lds
    s_add_u32 m0, s23, 11264
    s_mov_b32 s21, 1851392
    buffer_load_dwordx4 v21, s[12:15], s21 offen lds
    s_waitcnt vmcnt(32)
    ds_read_b64_tr_b16 a[48:49], v23 offset:12288
    ds_read_b64_tr_b16 a[50:51], v23 offset:13312
    ds_read_b64_tr_b16 a[52:53], v23 offset:14336
    ds_read_b64_tr_b16 a[54:55], v23 offset:15360
    ds_read_b64_tr_b16 a[56:57], v23 offset:12800
    ds_read_b64_tr_b16 a[58:59], v23 offset:13824
    ds_read_b64_tr_b16 a[60:61], v23 offset:14848
    ds_read_b64_tr_b16 a[62:63], v23 offset:15872
    s_waitcnt lgkmcnt(0)
    s_add_u32 m0, s23, 12288
    s_mov_b32 s21, 2621440
    buffer_load_dwordx4 v21, s[12:15], s21 offen lds
    s_add_u32 m0, s23, 13312
    s_mov_b32 s21, 2637824
    buffer_load_dwordx4 v21, s[12:15], s21 offen lds
    s_add_u32 m0, s23, 14336
    s_mov_b32 s21, 2883584
    buffer_load_dwordx4 v21, s[12:15], s21 offen lds
    s_add_u32 m0, s23, 15360
    s_mov_b32 s21, 2899968
    buffer_load_dwordx4 v21, s[12:15], s21 offen lds
    s_waitcnt vmcnt(32)
    ds_read_b64_tr_b16 a[64:65], v23 offset:16384
    ds_read_b64_tr_b16 a[66:67], v23 offset:17408
    ds_read_b64_tr_b16 a[68:69], v23 offset:18432
    ds_read_b64_tr_b16 a[70:71], v23 offset:19456
    ds_read_b64_tr_b16 a[72:73], v23 offset:16896
    ds_read_b64_tr_b16 a[74:75], v23 offset:17920
    ds_read_b64_tr_b16 a[76:77], v23 offset:18944
    ds_read_b64_tr_b16 a[78:79], v23 offset:19968
    s_waitcnt lgkmcnt(0)
    s_add_u32 m0, s23, 16384
    s_mov_b32 s21, 3145728
    buffer_load_dwordx4 v21, s[12:15], s21 offen lds
    s_add_u32 m0, s23, 17408
    s_mov_b32 s21, 3162112
    buffer_load_dwordx4 v21, s[12:15], s21 offen lds
    s_add_u32 m0, s23, 18432
    s_mov_b32 s21, 3407872
    buffer_load_dwordx4 v21, s[12:15], s21 offen lds
    s_add_u32 m0, s23, 19456
    s_mov_b32 s21, 3424256
    buffer_load_dwordx4 v21, s[12:15], s21 offen lds
    s_waitcnt vmcnt(32)
    ds_read_b64_tr_b16 a[80:81], v23 offset:20480
    ds_read_b64_tr_b16 a[82:83], v23 offset:21504
    ds_read_b64_tr_b16 a[84:85], v23 offset:22528
    ds_read_b64_tr_b16 a[86:87], v23 offset:23552
    ds_read_b64_tr_b16 a[88:89], v23 offset:20992
    ds_read_b64_tr_b16 a[90:91], v23 offset:22016
    ds_read_b64_tr_b16 a[92:93], v23 offset:23040
    ds_read_b64_tr_b16 a[94:95], v23 offset:24064
    s_waitcnt lgkmcnt(0)
    s_add_u32 m0, s23, 20480
    s_mov_b32 s21, 3670016
    buffer_load_dwordx4 v21, s[12:15], s21 offen lds
    s_add_u32 m0, s23, 21504
    s_mov_b32 s21, 3686400
    buffer_load_dwordx4 v21, s[12:15], s21 offen lds
    s_add_u32 m0, s23, 22528
    s_mov_b32 s21, 3932160
    buffer_load_dwordx4 v21, s[12:15], s21 offen lds
    s_add_u32 m0, s23, 23552
    s_mov_b32 s21, 3948544
    buffer_load_dwordx4 v21, s[12:15], s21 offen lds
    s_waitcnt vmcnt(32)
    ds_read_b64_tr_b16 a[96:97], v23 offset:24576
    ds_read_b64_tr_b16 a[98:99], v23 offset:25600
    ds_read_b64_tr_b16 a[100:101], v23 offset:26624
    ds_read_b64_tr_b16 a[102:103], v23 offset:27648
    ds_read_b64_tr_b16 a[104:105], v23 offset:25088
    ds_read_b64_tr_b16 a[106:107], v23 offset:26112
    ds_read_b64_tr_b16 a[108:109], v23 offset:27136
    ds_read_b64_tr_b16 a[110:111], v23 offset:28160
    s_waitcnt lgkmcnt(0)
    s_add_u32 m0, s23, 24576
    s_mov_b32 s21, 0
    buffer_load_dwordx4 v21, s[16:19], s21 offen lds
    s_add_u32 m0, s23, 25600
    s_mov_b32 s21, 16384
    buffer_load_dwordx4 v21, s[16:19], s21 offen lds
    s_add_u32 m0, s23, 26624
    s_mov_b32 s21, 262144
    buffer_load_dwordx4 v21, s[16:19], s21 offen lds
    s_add_u32 m0, s23, 27648
    s_mov_b32 s21, 278528
    buffer_load_dwordx4 v21, s[16:19], s21 offen lds
    s_waitcnt vmcnt(32)
    ds_read_b64_tr_b16 a[112:113], v23 offset:28672
    ds_read_b64_tr_b16 a[114:115], v23 offset:29696
    ds_read_b64_tr_b16 a[116:117], v23 offset:30720
    ds_read_b64_tr_b16 a[118:119], v23 offset:31744
    ds_read_b64_tr_b16 a[120:121], v23 offset:29184
    ds_read_b64_tr_b16 a[122:123], v23 offset:30208
    ds_read_b64_tr_b16 a[124:125], v23 offset:31232
    ds_read_b64_tr_b16 a[126:127], v23 offset:32256
    s_waitcnt lgkmcnt(0)
    s_add_u32 m0, s23, 28672
    s_mov_b32 s21, 524288
    buffer_load_dwordx4 v21, s[16:19], s21 offen lds
    s_add_u32 m0, s23, 29696
    s_mov_b32 s21, 540672
    buffer_load_dwordx4 v21, s[16:19], s21 offen lds
    s_add_u32 m0, s23, 30720
    s_mov_b32 s21, 786432
    buffer_load_dwordx4 v21, s[16:19], s21 offen lds
    s_add_u32 m0, s23, 31744
    s_mov_b32 s21, 802816
    buffer_load_dwordx4 v21, s[16:19], s21 offen lds
    s_waitcnt vmcnt(32)
    ds_read_b64_tr_b16 a[128:129], v23 offset:0
    ds_read_b64_tr_b16 a[130:131], v23 offset:1024
    ds_read_b64_tr_b16 a[132:133], v23 offset:2048
    ds_read_b64_tr_b16 a[134:135], v23 offset:3072
    ds_read_b64_tr_b16 a[136:137], v23 offset:512
    ds_read_b64_tr_b16 a[138:139], v23 offset:1536
    ds_read_b64_tr_b16 a[140:141], v23 offset:2560
    ds_read_b64_tr_b16 a[142:143], v23 offset:3584
    s_waitcnt lgkmcnt(0)
    s_add_u32 m0, s23, 0
    s_mov_b32 s21, 1048576
    buffer_load_dwordx4 v21, s[16:19], s21 offen lds
    s_add_u32 m0, s23, 1024
    s_mov_b32 s21, 1064960
    buffer_load_dwordx4 v21, s[16:19], s21 offen lds
    s_add_u32 m0, s23, 2048
    s_mov_b32 s21, 1310720
    buffer_load_dwordx4 v21, s[16:19], s21 offen lds
    s_add_u32 m0, s23, 3072
    s_mov_b32 s21, 1327104
    buffer_load_dwordx4 v21, s[16:19], s21 offen lds
    s_waitcnt vmcnt(28)
    ds_read_b64_tr_b16 a[144:145], v23 offset:4096
    ds_read_b64_tr_b16 a[146:147], v23 offset:5120
    ds_read_b64_tr_b16 a[148:149], v23 offset:6144
    ds_read_b64_tr_b16 a[150:151], v23 offset:7168
    ds_read_b64_tr_b16 a[152:153], v23 offset:4608
    ds_read_b64_tr_b16 a[154:155], v23 offset:5632
    ds_read_b64_tr_b16 a[156:157], v23 offset:6656
    ds_read_b64_tr_b16 a[158:159], v23 offset:7680
    s_waitcnt lgkmcnt(0)
    s_add_u32 m0, s23, 4096
    s_mov_b32 s21, 2097152
    buffer_load_dwordx4 v21, s[16:19], s21 offen lds
    s_add_u32 m0, s23, 5120
    s_mov_b32 s21, 2113536
    buffer_load_dwordx4 v21, s[16:19], s21 offen lds
    s_add_u32 m0, s23, 6144
    s_mov_b32 s21, 2359296
    buffer_load_dwordx4 v21, s[16:19], s21 offen lds
    s_add_u32 m0, s23, 7168
    s_mov_b32 s21, 2375680
    buffer_load_dwordx4 v21, s[16:19], s21 offen lds
    s_waitcnt vmcnt(28)
    ds_read_b64_tr_b16 a[160:161], v23 offset:8192
    ds_read_b64_tr_b16 a[162:163], v23 offset:9216
    ds_read_b64_tr_b16 a[164:165], v23 offset:10240
    ds_read_b64_tr_b16 a[166:167], v23 offset:11264
    ds_read_b64_tr_b16 a[168:169], v23 offset:8704
    ds_read_b64_tr_b16 a[170:171], v23 offset:9728
    ds_read_b64_tr_b16 a[172:173], v23 offset:10752
    ds_read_b64_tr_b16 a[174:175], v23 offset:11776
    s_waitcnt lgkmcnt(0)
    s_add_u32 m0, s23, 8192
    s_mov_b32 s21, 3145728
    buffer_load_dwordx4 v21, s[16:19], s21 offen lds
    s_add_u32 m0, s23, 9216
    s_mov_b32 s21, 3162112
    buffer_load_dwordx4 v21, s[16:19], s21 offen lds
    s_add_u32 m0, s23, 10240
    s_mov_b32 s21, 3407872
    buffer_load_dwordx4 v21, s[16:19], s21 offen lds
    s_add_u32 m0, s23, 11264
    s_mov_b32 s21, 3424256
    buffer_load_dwordx4 v21, s[16:19], s21 offen lds
    s_waitcnt vmcnt(28)
    ds_read_b64_tr_b16 a[176:177], v23 offset:12288
    ds_read_b64_tr_b16 a[178:179], v23 offset:13312
    ds_read_b64_tr_b16 a[180:181], v23 offset:14336
    ds_read_b64_tr_b16 a[182:183], v23 offset:15360
    ds_read_b64_tr_b16 a[184:185], v23 offset:12800
    ds_read_b64_tr_b16 a[186:187], v23 offset:13824
    ds_read_b64_tr_b16 a[188:189], v23 offset:14848
    ds_read_b64_tr_b16 a[190:191], v23 offset:15872
    s_waitcnt lgkmcnt(0)
    s_add_u32 m0, s23, 12288
    s_mov_b32 s21, 4194304
    buffer_load_dwordx4 v21, s[16:19], s21 offen lds
    s_add_u32 m0, s23, 13312
    s_mov_b32 s21, 4210688
    buffer_load_dwordx4 v21, s[16:19], s21 offen lds
    s_add_u32 m0, s23, 14336
    s_mov_b32 s21, 4456448
    buffer_load_dwordx4 v21, s[16:19], s21 offen lds
    s_add_u32 m0, s23, 15360
    s_mov_b32 s21, 4472832
    buffer_load_dwordx4 v21, s[16:19], s21 offen lds
    s_waitcnt vmcnt(28)
    ds_read_b64_tr_b16 a[192:193], v23 offset:16384
    ds_read_b64_tr_b16 a[194:195], v23 offset:17408
    ds_read_b64_tr_b16 a[196:197], v23 offset:18432
    ds_read_b64_tr_b16 a[198:199], v23 offset:19456
    ds_read_b64_tr_b16 a[200:201], v23 offset:16896
    ds_read_b64_tr_b16 a[202:203], v23 offset:17920
    ds_read_b64_tr_b16 a[204:205], v23 offset:18944
    ds_read_b64_tr_b16 a[206:207], v23 offset:19968
    s_waitcnt lgkmcnt(0)
    s_add_u32 m0, s23, 16384
    s_mov_b32 s21, 0
    buffer_load_dwordx4 v22, s[24:27], s21 offen lds
    s_add_u32 m0, s23, 17408
    s_mov_b32 s21, 2304
    buffer_load_dwordx4 v22, s[24:27], s21 offen lds
    s_add_u32 m0, s23, 18432
    s_mov_b32 s21, 36864
    buffer_load_dwordx4 v22, s[24:27], s21 offen lds
    s_add_u32 m0, s23, 19456
    s_mov_b32 s21, 39168
    buffer_load_dwordx4 v22, s[24:27], s21 offen lds
    s_waitcnt vmcnt(28)
    ds_read_b64_tr_b16 a[208:209], v23 offset:20480
    ds_read_b64_tr_b16 a[210:211], v23 offset:21504
    ds_read_b64_tr_b16 a[212:213], v23 offset:22528
    ds_read_b64_tr_b16 a[214:215], v23 offset:23552
    ds_read_b64_tr_b16 a[216:217], v23 offset:20992
    ds_read_b64_tr_b16 a[218:219], v23 offset:22016
    ds_read_b64_tr_b16 a[220:221], v23 offset:23040
    ds_read_b64_tr_b16 a[222:223], v23 offset:24064
    s_waitcnt lgkmcnt(0)
    s_add_u32 m0, s23, 20480
    s_mov_b32 s21, 64
    buffer_load_dwordx4 v22, s[24:27], s21 offen lds
    s_add_u32 m0, s23, 21504
    s_mov_b32 s21, 2368
    buffer_load_dwordx4 v22, s[24:27], s21 offen lds
    s_add_u32 m0, s23, 22528
    s_mov_b32 s21, 36928
    buffer_load_dwordx4 v22, s[24:27], s21 offen lds
    s_add_u32 m0, s23, 23552
    s_mov_b32 s21, 39232
    buffer_load_dwordx4 v22, s[24:27], s21 offen lds
    s_waitcnt vmcnt(28)
    ds_read_b64_tr_b16 a[224:225], v23 offset:24576
    ds_read_b64_tr_b16 a[226:227], v23 offset:25600
    ds_read_b64_tr_b16 a[228:229], v23 offset:26624
    ds_read_b64_tr_b16 a[230:231], v23 offset:27648
    ds_read_b64_tr_b16 a[232:233], v23 offset:25088
    ds_read_b64_tr_b16 a[234:235], v23 offset:26112
    ds_read_b64_tr_b16 a[236:237], v23 offset:27136
    ds_read_b64_tr_b16 a[238:239], v23 offset:28160
    s_waitcnt lgkmcnt(0)
    s_add_u32 m0, s23, 24576
    s_mov_b32 s21, 128
    buffer_load_dwordx4 v22, s[24:27], s21 offen lds
    s_add_u32 m0, s23, 25600
    s_mov_b32 s21, 2432
    buffer_load_dwordx4 v22, s[24:27], s21 offen lds
    s_add_u32 m0, s23, 26624
    s_mov_b32 s21, 36992
    buffer_load_dwordx4 v22, s[24:27], s21 offen lds
    s_add_u32 m0, s23, 27648
    s_mov_b32 s21, 39296
    buffer_load_dwordx4 v22, s[24:27], s21 offen lds
    s_waitcnt vmcnt(28)
    ds_read_b64_tr_b16 a[240:241], v23 offset:28672
    ds_read_b64_tr_b16 a[242:243], v23 offset:29696
    ds_read_b64_tr_b16 a[244:245], v23 offset:30720
    ds_read_b64_tr_b16 a[246:247], v23 offset:31744
    ds_read_b64_tr_b16 a[248:249], v23 offset:29184
    ds_read_b64_tr_b16 a[250:251], v23 offset:30208
    ds_read_b64_tr_b16 a[252:253], v23 offset:31232
    ds_read_b64_tr_b16 a[254:255], v23 offset:32256
    s_waitcnt lgkmcnt(0)
    s_add_u32 m0, s23, 28672
    s_mov_b32 s21, 192
    buffer_load_dwordx4 v22, s[24:27], s21 offen lds
    s_add_u32 m0, s23, 29696
    s_mov_b32 s21, 2496
    buffer_load_dwordx4 v22, s[24:27], s21 offen lds
    s_add_u32 m0, s23, 30720
    s_mov_b32 s21, 37056
    buffer_load_dwordx4 v22, s[24:27], s21 offen lds
    s_add_u32 m0, s23, 31744
    s_mov_b32 s21, 39360
    buffer_load_dwordx4 v22, s[24:27], s21 offen lds
    s_waitcnt vmcnt(28)
    ds_read_b64_tr_b16 v[72:73], v23 offset:0
    ds_read_b64_tr_b16 v[74:75], v23 offset:1024
    ds_read_b64_tr_b16 v[76:77], v23 offset:2048
    ds_read_b64_tr_b16 v[78:79], v23 offset:3072
    ds_read_b64_tr_b16 v[80:81], v23 offset:512
    ds_read_b64_tr_b16 v[82:83], v23 offset:1536
    ds_read_b64_tr_b16 v[84:85], v23 offset:2560
    ds_read_b64_tr_b16 v[86:87], v23 offset:3584
    s_waitcnt lgkmcnt(0)
    s_add_u32 m0, s23, 0
    s_mov_b32 s21, 256
    buffer_load_dwordx4 v22, s[24:27], s21 offen lds
    s_add_u32 m0, s23, 1024
    s_mov_b32 s21, 2560
    buffer_load_dwordx4 v22, s[24:27], s21 offen lds
    s_add_u32 m0, s23, 2048
    s_mov_b32 s21, 37120
    buffer_load_dwordx4 v22, s[24:27], s21 offen lds
    s_add_u32 m0, s23, 3072
    s_mov_b32 s21, 39424
    buffer_load_dwordx4 v22, s[24:27], s21 offen lds
    s_waitcnt vmcnt(28)
    ds_read_b64_tr_b16 v[88:89], v23 offset:4096
    ds_read_b64_tr_b16 v[90:91], v23 offset:5120
    ds_read_b64_tr_b16 v[92:93], v23 offset:6144
    ds_read_b64_tr_b16 v[94:95], v23 offset:7168
    ds_read_b64_tr_b16 v[96:97], v23 offset:4608
    ds_read_b64_tr_b16 v[98:99], v23 offset:5632
    ds_read_b64_tr_b16 v[100:101], v23 offset:6656
    ds_read_b64_tr_b16 v[102:103], v23 offset:7680
    s_waitcnt lgkmcnt(0)
    s_add_u32 m0, s23, 4096
    s_mov_b32 s21, 73728
    buffer_load_dwordx4 v22, s[24:27], s21 offen lds
    s_add_u32 m0, s23, 5120
    s_mov_b32 s21, 76032
    buffer_load_dwordx4 v22, s[24:27], s21 offen lds
    s_add_u32 m0, s23, 6144
    s_mov_b32 s21, 110592
    buffer_load_dwordx4 v22, s[24:27], s21 offen lds
    s_add_u32 m0, s23, 7168
    s_mov_b32 s21, 112896
    buffer_load_dwordx4 v22, s[24:27], s21 offen lds
    s_waitcnt vmcnt(28)
    ds_read_b64_tr_b16 v[104:105], v23 offset:8192
    ds_read_b64_tr_b16 v[106:107], v23 offset:9216
    ds_read_b64_tr_b16 v[108:109], v23 offset:10240
    ds_read_b64_tr_b16 v[110:111], v23 offset:11264
    ds_read_b64_tr_b16 v[112:113], v23 offset:8704
    ds_read_b64_tr_b16 v[114:115], v23 offset:9728
    ds_read_b64_tr_b16 v[116:117], v23 offset:10752
    ds_read_b64_tr_b16 v[118:119], v23 offset:11776
    s_waitcnt lgkmcnt(0)
    s_add_u32 m0, s23, 8192
    s_mov_b32 s21, 73792
    buffer_load_dwordx4 v22, s[24:27], s21 offen lds
    s_add_u32 m0, s23, 9216
    s_mov_b32 s21, 76096
    buffer_load_dwordx4 v22, s[24:27], s21 offen lds
    s_add_u32 m0, s23, 10240
    s_mov_b32 s21, 110656
    buffer_load_dwordx4 v22, s[24:27], s21 offen lds
    s_add_u32 m0, s23, 11264
    s_mov_b32 s21, 112960
    buffer_load_dwordx4 v22, s[24:27], s21 offen lds
    s_waitcnt vmcnt(28)
    ds_read_b64_tr_b16 v[120:121], v23 offset:12288
    ds_read_b64_tr_b16 v[122:123], v23 offset:13312
    ds_read_b64_tr_b16 v[124:125], v23 offset:14336
    ds_read_b64_tr_b16 v[126:127], v23 offset:15360
    ds_read_b64_tr_b16 v[128:129], v23 offset:12800
    ds_read_b64_tr_b16 v[130:131], v23 offset:13824
    ds_read_b64_tr_b16 v[132:133], v23 offset:14848
    ds_read_b64_tr_b16 v[134:135], v23 offset:15872
    s_waitcnt lgkmcnt(0)
    s_add_u32 m0, s23, 12288
    s_mov_b32 s21, 73856
    buffer_load_dwordx4 v22, s[24:27], s21 offen lds
    s_add_u32 m0, s23, 13312
    s_mov_b32 s21, 76160
    buffer_load_dwordx4 v22, s[24:27], s21 offen lds
    s_add_u32 m0, s23, 14336
    s_mov_b32 s21, 110720
    buffer_load_dwordx4 v22, s[24:27], s21 offen lds
    s_add_u32 m0, s23, 15360
    s_mov_b32 s21, 113024
    buffer_load_dwordx4 v22, s[24:27], s21 offen lds
    s_waitcnt vmcnt(28)
    ds_read_b64_tr_b16 v[136:137], v23 offset:16384
    ds_read_b64_tr_b16 v[138:139], v23 offset:17408
    ds_read_b64_tr_b16 v[140:141], v23 offset:18432
    ds_read_b64_tr_b16 v[142:143], v23 offset:19456
    ds_read_b64_tr_b16 v[144:145], v23 offset:16896
    ds_read_b64_tr_b16 v[146:147], v23 offset:17920
    ds_read_b64_tr_b16 v[148:149], v23 offset:18944
    ds_read_b64_tr_b16 v[150:151], v23 offset:19968
    s_waitcnt lgkmcnt(0)
    s_add_u32 m0, s23, 16384
    s_mov_b32 s21, 1572864
    buffer_load_dwordx4 v21, s[16:19], s21 offen lds
    s_add_u32 m0, s23, 17408
    s_mov_b32 s21, 1589248
    buffer_load_dwordx4 v21, s[16:19], s21 offen lds
    s_add_u32 m0, s23, 18432
    s_mov_b32 s21, 1835008
    buffer_load_dwordx4 v21, s[16:19], s21 offen lds
    s_add_u32 m0, s23, 19456
    s_mov_b32 s21, 1851392
    buffer_load_dwordx4 v21, s[16:19], s21 offen lds
    s_waitcnt vmcnt(28)
    ds_read_b64_tr_b16 v[152:153], v23 offset:20480
    ds_read_b64_tr_b16 v[154:155], v23 offset:21504
    ds_read_b64_tr_b16 v[156:157], v23 offset:22528
    ds_read_b64_tr_b16 v[158:159], v23 offset:23552
    ds_read_b64_tr_b16 v[160:161], v23 offset:20992
    ds_read_b64_tr_b16 v[162:163], v23 offset:22016
    ds_read_b64_tr_b16 v[164:165], v23 offset:23040
    ds_read_b64_tr_b16 v[166:167], v23 offset:24064
    s_waitcnt lgkmcnt(0)
    s_add_u32 m0, s23, 20480
    s_mov_b32 s21, 2621440
    buffer_load_dwordx4 v21, s[16:19], s21 offen lds
    s_add_u32 m0, s23, 21504
    s_mov_b32 s21, 2637824
    buffer_load_dwordx4 v21, s[16:19], s21 offen lds
    s_add_u32 m0, s23, 22528
    s_mov_b32 s21, 2883584
    buffer_load_dwordx4 v21, s[16:19], s21 offen lds
    s_add_u32 m0, s23, 23552
    s_mov_b32 s21, 2899968
    buffer_load_dwordx4 v21, s[16:19], s21 offen lds
    s_waitcnt vmcnt(28)
    ds_read_b64_tr_b16 v[168:169], v23 offset:24576
    ds_read_b64_tr_b16 v[170:171], v23 offset:25600
    ds_read_b64_tr_b16 v[172:173], v23 offset:26624
    ds_read_b64_tr_b16 v[174:175], v23 offset:27648
    ds_read_b64_tr_b16 v[176:177], v23 offset:25088
    ds_read_b64_tr_b16 v[178:179], v23 offset:26112
    ds_read_b64_tr_b16 v[180:181], v23 offset:27136
    ds_read_b64_tr_b16 v[182:183], v23 offset:28160
    s_waitcnt lgkmcnt(0)
    s_add_u32 m0, s23, 24576
    s_mov_b32 s21, 3670016
    buffer_load_dwordx4 v21, s[16:19], s21 offen lds
    s_add_u32 m0, s23, 25600
    s_mov_b32 s21, 3686400
    buffer_load_dwordx4 v21, s[16:19], s21 offen lds
    s_add_u32 m0, s23, 26624
    s_mov_b32 s21, 3932160
    buffer_load_dwordx4 v21, s[16:19], s21 offen lds
    s_add_u32 m0, s23, 27648
    s_mov_b32 s21, 3948544
    buffer_load_dwordx4 v21, s[16:19], s21 offen lds
    s_waitcnt vmcnt(28)
    ds_read_b64_tr_b16 v[184:185], v23 offset:28672
    ds_read_b64_tr_b16 v[186:187], v23 offset:29696
    ds_read_b64_tr_b16 v[188:189], v23 offset:30720
    ds_read_b64_tr_b16 v[190:191], v23 offset:31744
    ds_read_b64_tr_b16 v[192:193], v23 offset:29184
    ds_read_b64_tr_b16 v[194:195], v23 offset:30208
    ds_read_b64_tr_b16 v[196:197], v23 offset:31232
    ds_read_b64_tr_b16 v[198:199], v23 offset:32256
    s_waitcnt lgkmcnt(0)
    s_add_u32 m0, s23, 28672
    s_mov_b32 s21, 73920
    buffer_load_dwordx4 v22, s[24:27], s21 offen lds
    s_add_u32 m0, s23, 29696
    s_mov_b32 s21, 76224
    buffer_load_dwordx4 v22, s[24:27], s21 offen lds
    s_add_u32 m0, s23, 30720
    s_mov_b32 s21, 110784
    buffer_load_dwordx4 v22, s[24:27], s21 offen lds
    s_add_u32 m0, s23, 31744
    s_mov_b32 s21, 113088
    buffer_load_dwordx4 v22, s[24:27], s21 offen lds
    s_waitcnt vmcnt(28)
    ds_read_b64_tr_b16 v[200:201], v23 offset:0
    ds_read_b64_tr_b16 v[202:203], v23 offset:1024
    ds_read_b64_tr_b16 v[204:205], v23 offset:2048
    ds_read_b64_tr_b16 v[206:207], v23 offset:3072
    s_waitcnt lgkmcnt(0)
    s_add_u32 m0, s23, 0
    s_mov_b32 s21, 1048576
    buffer_load_dwordx4 v21, s[8:11], s21 offen lds
    s_add_u32 m0, s23, 1024
    s_mov_b32 s21, 1064960
    buffer_load_dwordx4 v21, s[8:11], s21 offen lds
    s_add_u32 m0, s23, 2048
    s_mov_b32 s21, 1310720
    buffer_load_dwordx4 v21, s[8:11], s21 offen lds
    s_add_u32 m0, s23, 3072
    s_mov_b32 s21, 1327104
    buffer_load_dwordx4 v21, s[8:11], s21 offen lds
    s_waitcnt vmcnt(28)
    ds_read_b64_tr_b16 v[208:209], v23 offset:4096
    ds_read_b64_tr_b16 v[210:211], v23 offset:5120
    ds_read_b64_tr_b16 v[212:213], v23 offset:6144
    ds_read_b64_tr_b16 v[214:215], v23 offset:7168
    ds_read_b64_tr_b16 v[216:217], v23 offset:4608
    ds_read_b64_tr_b16 v[218:219], v23 offset:5632
    ds_read_b64_tr_b16 v[220:221], v23 offset:6656
    ds_read_b64_tr_b16 v[222:223], v23 offset:7680
    s_waitcnt lgkmcnt(0)
    s_add_u32 m0, s23, 4096
    s_mov_b32 s21, 2097152
    buffer_load_dwordx4 v21, s[12:15], s21 offen lds
    s_add_u32 m0, s23, 5120
    s_mov_b32 s21, 2113536
    buffer_load_dwordx4 v21, s[12:15], s21 offen lds
    s_add_u32 m0, s23, 6144
    s_mov_b32 s21, 2359296
    buffer_load_dwordx4 v21, s[12:15], s21 offen lds
    s_add_u32 m0, s23, 7168
    s_mov_b32 s21, 2375680
    buffer_load_dwordx4 v21, s[12:15], s21 offen lds
    s_waitcnt vmcnt(28)
    ds_read_b64_tr_b16 v[224:225], v23 offset:8192
    ds_read_b64_tr_b16 v[226:227], v23 offset:9216
    ds_read_b64_tr_b16 v[228:229], v23 offset:10240
    ds_read_b64_tr_b16 v[230:231], v23 offset:11264
    ds_read_b64_tr_b16 v[232:233], v23 offset:8704
    ds_read_b64_tr_b16 v[234:235], v23 offset:9728
    ds_read_b64_tr_b16 v[236:237], v23 offset:10752
    ds_read_b64_tr_b16 v[238:239], v23 offset:11776
    s_waitcnt lgkmcnt(0)
    s_add_u32 m0, s23, 8192
    s_mov_b32 s21, 3145728
    buffer_load_dwordx4 v21, s[8:11], s21 offen lds
    s_add_u32 m0, s23, 9216
    s_mov_b32 s21, 3162112
    buffer_load_dwordx4 v21, s[8:11], s21 offen lds
    s_add_u32 m0, s23, 10240
    s_mov_b32 s21, 3407872
    buffer_load_dwordx4 v21, s[8:11], s21 offen lds
    s_add_u32 m0, s23, 11264
    s_mov_b32 s21, 3424256
    buffer_load_dwordx4 v21, s[8:11], s21 offen lds
    s_waitcnt vmcnt(28)
    ds_read_b64_tr_b16 v[240:241], v23 offset:12288
    ds_read_b64_tr_b16 v[242:243], v23 offset:13312
    ds_read_b64_tr_b16 v[244:245], v23 offset:14336
    ds_read_b64_tr_b16 v[246:247], v23 offset:15360
    ds_read_b64_tr_b16 v[248:249], v23 offset:12800
    ds_read_b64_tr_b16 v[250:251], v23 offset:13824
    ds_read_b64_tr_b16 v[252:253], v23 offset:14848
    ds_read_b64_tr_b16 v[254:255], v23 offset:15872
    s_waitcnt lgkmcnt(0)
    s_add_u32 m0, s23, 12288
    s_mov_b32 s21, 4194304
    buffer_load_dwordx4 v21, s[12:15], s21 offen lds
    s_add_u32 m0, s23, 13312
    s_mov_b32 s21, 4210688
    buffer_load_dwordx4 v21, s[12:15], s21 offen lds
    s_add_u32 m0, s23, 14336
    s_mov_b32 s21, 4456448
    buffer_load_dwordx4 v21, s[12:15], s21 offen lds
    s_add_u32 m0, s23, 15360
    s_mov_b32 s21, 4472832
    buffer_load_dwordx4 v21, s[12:15], s21 offen lds
    s_waitcnt vmcnt(0)
    ds_read_b64_tr_b16 v[28:29], v23 offset:0
    ds_read_b64_tr_b16 v[30:31], v23 offset:1024
    ds_read_b64_tr_b16 v[32:33], v23 offset:2048
    ds_read_b64_tr_b16 v[34:35], v23 offset:3072
    ds_read_b64_tr_b16 v[36:37], v23 offset:512
    ds_read_b64_tr_b16 v[38:39], v23 offset:1536
    ds_read_b64_tr_b16 v[40:41], v23 offset:2560
    ds_read_b64_tr_b16 v[42:43], v23 offset:3584
    s_waitcnt lgkmcnt(0)
    ds_write_b128 v10, v[28:31] offset:0
    ds_write_b128 v10, v[32:35] offset:1024
    ds_write_b128 v10, v[36:39] offset:2048
    ds_write_b128 v10, v[40:43] offset:3072
    s_waitcnt lgkmcnt(0)
    ds_read_b64_tr_b16 v[28:29], v23 offset:4096
    ds_read_b64_tr_b16 v[30:31], v23 offset:5120
    ds_read_b64_tr_b16 v[32:33], v23 offset:6144
    ds_read_b64_tr_b16 v[34:35], v23 offset:7168
    ds_read_b64_tr_b16 v[36:37], v23 offset:4608
    ds_read_b64_tr_b16 v[38:39], v23 offset:5632
    ds_read_b64_tr_b16 v[40:41], v23 offset:6656
    ds_read_b64_tr_b16 v[42:43], v23 offset:7680
    s_waitcnt lgkmcnt(0)
    ds_write_b128 v10, v[28:31] offset:4096
    ds_write_b128 v10, v[32:35] offset:5120
    ds_write_b128 v10, v[36:39] offset:6144
    ds_write_b128 v10, v[40:43] offset:7168
    s_waitcnt lgkmcnt(0)
    ds_read_b64_tr_b16 v[28:29], v23 offset:8192
    ds_read_b64_tr_b16 v[30:31], v23 offset:9216
    ds_read_b64_tr_b16 v[32:33], v23 offset:10240
    ds_read_b64_tr_b16 v[34:35], v23 offset:11264
    ds_read_b64_tr_b16 v[36:37], v23 offset:8704
    ds_read_b64_tr_b16 v[38:39], v23 offset:9728
    ds_read_b64_tr_b16 v[40:41], v23 offset:10752
    ds_read_b64_tr_b16 v[42:43], v23 offset:11776
    s_waitcnt lgkmcnt(0)
    ds_write_b128 v10, v[28:31] offset:8192
    ds_write_b128 v10, v[32:35] offset:9216
    ds_write_b128 v10, v[36:39] offset:10240
    ds_write_b128 v10, v[40:43] offset:11264
    s_waitcnt lgkmcnt(0)
    ds_read_b64_tr_b16 v[28:29], v23 offset:12288
    ds_read_b64_tr_b16 v[30:31], v23 offset:13312
    ds_read_b64_tr_b16 v[32:33], v23 offset:14336
    ds_read_b64_tr_b16 v[34:35], v23 offset:15360
    ds_read_b64_tr_b16 v[36:37], v23 offset:12800
    ds_read_b64_tr_b16 v[38:39], v23 offset:13824
    ds_read_b64_tr_b16 v[40:41], v23 offset:14848
    ds_read_b64_tr_b16 v[42:43], v23 offset:15872
    s_waitcnt lgkmcnt(0)
    ds_write_b128 v10, v[28:31] offset:12288
    ds_write_b128 v10, v[32:35] offset:13312
    ds_write_b128 v10, v[36:39] offset:14336
    ds_write_b128 v10, v[40:43] offset:15360
    s_waitcnt lgkmcnt(0)
    ds_read_b64_tr_b16 v[28:29], v23 offset:16384
    ds_read_b64_tr_b16 v[30:31], v23 offset:17408
    ds_read_b64_tr_b16 v[32:33], v23 offset:18432
    ds_read_b64_tr_b16 v[34:35], v23 offset:19456
    ds_read_b64_tr_b16 v[36:37], v23 offset:16896
    ds_read_b64_tr_b16 v[38:39], v23 offset:17920
    ds_read_b64_tr_b16 v[40:41], v23 offset:18944
    ds_read_b64_tr_b16 v[42:43], v23 offset:19968
    s_waitcnt lgkmcnt(0)
    ds_write_b128 v10, v[28:31] offset:16384
    ds_write_b128 v10, v[32:35] offset:17408
    ds_write_b128 v10, v[36:39] offset:18432
    ds_write_b128 v10, v[40:43] offset:19456
    s_waitcnt lgkmcnt(0)
    ds_read_b64_tr_b16 v[28:29], v23 offset:20480
    ds_read_b64_tr_b16 v[30:31], v23 offset:21504
    ds_read_b64_tr_b16 v[32:33], v23 offset:22528
    ds_read_b64_tr_b16 v[34:35], v23 offset:23552
    ds_read_b64_tr_b16 v[36:37], v23 offset:20992
    ds_read_b64_tr_b16 v[38:39], v23 offset:22016
    ds_read_b64_tr_b16 v[40:41], v23 offset:23040
    ds_read_b64_tr_b16 v[42:43], v23 offset:24064
    s_waitcnt lgkmcnt(0)
    ds_write_b128 v10, v[28:31] offset:20480
    ds_write_b128 v10, v[32:35] offset:21504
    ds_write_b128 v10, v[36:39] offset:22528
    ds_write_b128 v10, v[40:43] offset:23552
    s_waitcnt lgkmcnt(0)
    ds_read_b64_tr_b16 v[28:29], v23 offset:24576
    ds_read_b64_tr_b16 v[30:31], v23 offset:25600
    ds_read_b64_tr_b16 v[32:33], v23 offset:26624
    ds_read_b64_tr_b16 v[34:35], v23 offset:27648
    ds_read_b64_tr_b16 v[36:37], v23 offset:25088
    ds_read_b64_tr_b16 v[38:39], v23 offset:26112
    ds_read_b64_tr_b16 v[40:41], v23 offset:27136
    ds_read_b64_tr_b16 v[42:43], v23 offset:28160
    s_waitcnt lgkmcnt(0)
    ds_write_b128 v10, v[28:31] offset:24576
    ds_write_b128 v10, v[32:35] offset:25600
    ds_write_b128 v10, v[36:39] offset:26624
    ds_write_b128 v10, v[40:43] offset:27648
    s_waitcnt lgkmcnt(0)
    ds_read_b64_tr_b16 v[28:29], v23 offset:28672
    ds_read_b64_tr_b16 v[30:31], v23 offset:29696
    ds_read_b64_tr_b16 v[32:33], v23 offset:30720
    ds_read_b64_tr_b16 v[34:35], v23 offset:31744
    ds_read_b64_tr_b16 v[36:37], v23 offset:29184
    ds_read_b64_tr_b16 v[38:39], v23 offset:30208
    ds_read_b64_tr_b16 v[40:41], v23 offset:31232
    ds_read_b64_tr_b16 v[42:43], v23 offset:32256
    s_waitcnt lgkmcnt(0)
    ds_write_b128 v10, v[28:31] offset:28672
    ds_write_b128 v10, v[32:35] offset:29696
    ds_write_b128 v10, v[36:39] offset:30720
    ds_write_b128 v10, v[40:43] offset:31744
    s_waitcnt lgkmcnt(0)
    ds_read_b64_tr_b16 v[28:29], v24 offset:0
    ds_read_b64_tr_b16 v[30:31], v24 offset:1024
    ds_read_b64_tr_b16 v[32:33], v24 offset:2048
    ds_read_b64_tr_b16 v[34:35], v24 offset:3072
    s_waitcnt lgkmcnt(0)
    ds_write_b128 v10, v[28:31] offset:32768
    ds_write_b128 v10, v[32:35] offset:33792
    s_waitcnt lgkmcnt(0)
    s_barrier
    v_add_u32 v11, 139264, v1
    v_and_b32 v16, 15, v0
    v_lshrrev_b32 v17, 4, v0
    v_mov_b32 v2, 0x4444
    v_mov_b32 v18, 0xeeee
    v_cmp_lt_u32 vcc, 7, v16
    v_cndmask_b32 v2, v2, v18, vcc
    v_bfe_u32 v18, v0, 2, 2
    v_lshl_add_u32 v18, v17, 2, v18
    v_lshlrev_b32 v18, 4, v18
    v_and_b32 v19, 1, v0
    v_lshl_add_u32 v18, v19, 3, v18
    v_add_u32 v3, 156672, v18
    v_lshrrev_b32 v18, 5, v0
    v_lshl_add_u32 v18, v18, 4, v16
    v_lshlrev_b32 v18, 4, v18
    v_and_b32 v19, 1, v17
    v_lshl_add_u32 v18, v19, 3, v18
    s_lshl_b32 s21, s20, 9
    s_add_u32 s21, s21, 156672
    v_add_u32 v6, s21, v18
    v_and_b32 v18, 7, v16
    v_mul_u32_u24 v18, 272, v18
    v_lshl_add_u32 v4, v17, 3, v18
    s_lshl_b32 s21, s20, 6
    s_add_u32 s21, s21, 147456
    v_add_u32 v4, s21, v4
    v_lshl_add_u32 v5, v17, 5, v18
    v_lshrrev_b32 v19, 3, v16
    v_lshl_add_u32 v5, v19, 4, v5
    v_add_u32 v5, 147456, v5
    v_and_b32 v18, 1, v17
    v_lshlrev_b32 v18, 1, v18
    v_lshrrev_b32 v19, 1, v17
    v_add_u32 v18, v18, v19
    v_lshl_add_u32 v18, v18, 4, v16
    v_lshlrev_b32 v18, 4, v18
    s_mul_i32 s21, s70, 9216
    s_mul_i32 s22, s20, 2304
    s_add_u32 s21, s21, s22
    v_add_u32 v7, s21, v18
    s_lshl_b32 s41, s20, 5
    s_add_u32 s41, s41, s70
    v_lshrrev_b32 v18, 3, v16
    v_lshl_add_u32 v18, v17, 1, v18
    v_mul_u32_u24 v18, 9216, v18
    v_and_b32 v19, 7, v16
    v_lshl_add_u32 v18, v19, 4, v18
    s_lshl_b32 s21, s41, 7
    v_add_u32 v8, s21, v18
    v_lshlrev_b32 v19, 4, v19
    v_add_u32 v9, s21, v19
    v_and_b32 v16, 15, v0
    v_lshrrev_b32 v17, 1, v16
    v_and_b32 v18, 1, v16
    v_mov_b32 v19, 0x3f80
    v_lshlrev_b32 v18, 4, v18
    v_lshlrev_b32 v19, v18, v19
    v_cmp_eq_u32 vcc, 0, v17
    v_cndmask_b32 v44, 0, v19, vcc
    v_cmp_eq_u32 vcc, 1, v17
    v_cndmask_b32 v45, 0, v19, vcc
    v_cmp_eq_u32 vcc, 2, v17
    v_cndmask_b32 v46, 0, v19, vcc
    v_cmp_eq_u32 vcc, 3, v17
    v_cndmask_b32 v47, 0, v19, vcc
    ds_write_b128 v11, v[44:47] offset:21504
    s_mov_b32 s46, 400000
    v_mov_b32 v17, 64
CB_9:
    buffer_load_dword v16, v17, s[56:59], 0 offen sc1
    s_waitcnt vmcnt(0)
    v_readfirstlane_b32 s21, v16
    s_cmp_ge_u32 s21, 32
    s_cbranch_scc1 CBO_10
    s_sub_u32 s46, s46, 1
    s_cmp_gt_i32 s46, 0
    s_cbranch_scc1 CB_9
CBO_10:
    s_add_u32 s64, s74, 92274688
    s_addc_u32 s65, s75, 0
    s_mov_b32 s66, 20480
    s_mov_b32 s67, 0x00020000
    s_mov_b32 s60, 0
    s_mov_b32 s44, 0
    s_mov_b32 s42, 0
    s_cmp_gt_u32 s60, s42
    s_cbranch_scc1 RD_11
    v_and_b32 v17, 1, v0
    v_lshlrev_b32 v17, 12, v17
    s_lshl_b32 s61, s70, 7
    v_add_u32 v17, s61, v17
    s_mov_b32 s63, 200000
RP_12:
    buffer_load_dword v16, v17, s[64:67], 0 offen sc1
    s_waitcnt vmcnt(0)
    v_readlane_b32 s61, v16, 0
    v_readlane_b32 s62, v16, 1
    s_min_u32 s60, s61, s62
    s_cmp_gt_u32 s60, s42
    s_cbranch_scc1 RD_11
    s_sub_u32 s63, s63, 1
    s_cmp_gt_i32 s63, 0
    s_cbranch_scc1 RP_12
RD_11:
    s_lshl_b32 s71, s42, 5
    s_add_u32 s71, s71, s70
    s_lshl_b32 s71, s71, 13
    s_lshl_b32 s42, s20, 11
    s_add_u32 s71, s71, s42
    s_mov_b32 m0, 161792
    s_nop 0
    buffer_load_dwordx4 v1, s[32:35], s71 offen offset:0 sc1 lds
    buffer_load_dwordx4 v1, s[32:35], s71 offen offset:1024 sc1 lds
    buffer_load_dwordx4 v1, s[36:39], s71 offen offset:0 sc1 lds
    buffer_load_dwordx4 v1, s[36:39], s71 offen offset:1024 sc1 lds
    v_and_b32 v16, 7, v0
    v_mul_u32_u24 v16, 1152, v16
    v_lshrrev_b32 v17, 4, v0
    v_lshl_add_u32 v16, v17, 5, v16
    v_bfe_u32 v17, v0, 3, 1
    v_lshl_add_u32 v16, v17, 4, v16
    s_lshl_b32 s21, s20, 7
    buffer_load_dwordx4 v[20:23], v16, s[52:55], s21 offen
    buffer_load_dwordx4 v[24:27], v16, s[52:55], s21 offen offset:512
    buffer_load_dwordx4 v[28:31], v16, s[52:55], 0 offen offset:1024
    s_waitcnt vmcnt(0)
    v_mov_b32 v44, 0
    v_mov_b32 v45, 0
    v_mov_b32 v46, 0
    v_mov_b32 v47, 0
    v_mov_b32 v48, 0
    v_mov_b32 v49, 0
    v_mov_b32 v50, 0
    v_mov_b32 v51, 0
    v_mov_b32 v52, 0
    v_mov_b32 v53, 0
    v_mov_b32 v54, 0
    v_mov_b32 v55, 0
    v_mov_b32 v56, 0
    v_mov_b32 v57, 0
    v_mov_b32 v58, 0
    v_mov_b32 v59, 0
    v_mov_b32 v60, 0
    v_mov_b32 v61, 0
    v_mov_b32 v62, 0
    v_mov_b32 v63, 0
    v_mov_b32 v64, 0
    v_mov_b32 v65, 0
    v_mov_b32 v66, 0
    v_mov_b32 v67, 0
    s_branch CH_13
CL_14:
    s_sub_u32 s21, s44, 1
    s_and_b32 s22, s21, 1
    s_lshl_b32 s22, s22, 14
    s_add_u32 s22, s22, 1048576
    s_lshl_b32 s42, s20, 10
    s_add_u32 s47, s22, 8192
    s_add_u32 s22, s22, s42
    s_lshr_b32 s21, s21, 1
    s_and_b32 s45, s21, 1
    s_add_u32 s43, s22, 4096
CP_16:
    buffer_load_dwordx4 v[20:23], v1, s[28:31], s22 offen sc1
    buffer_load_dwordx4 v[24:27], v1, s[28:31], s43 offen sc1
    buffer_load_dwordx4 v[28:31], v1, s[28:31], s47 offen sc1
    s_waitcnt vmcnt(0)
    v_xor_b32 v16, s45, v20
    v_xor_b32 v17, s45, v24
    v_xor_b32 v18, s45, v28
    v_or3_b32 v16, v16, v17, v18
    v_and_b32 v16, 1, v16
    v_cmp_ne_u32 vcc, 0, v16
    s_cbranch_vccz CH_13
    s_sub_u32 s46, s46, 1
    s_cmp_gt_i32 s46, 0
    s_cbranch_scc1 CP_16
CH_13:
    s_lshl_b32 s21, s20, 10
    v_add_u32 v16, s21, v11
    ds_write_b128 v16, v[20:23] offset:8192
    ds_write_b128 v16, v[24:27] offset:12288
    ds_write_b128 v11, v[28:31] offset:16384
    v_pk_mov_b32 v[44:45], 0, 0
    v_pk_mov_b32 v[46:47], 0, 0
    v_pk_mov_b32 v[48:49], 0, 0
    v_pk_mov_b32 v[50:51], 0, 0
    v_pk_mov_b32 v[52:53], 0, 0
    v_pk_mov_b32 v[54:55], 0, 0
    v_pk_mov_b32 v[56:57], 0, 0
    v_pk_mov_b32 v[58:59], 0, 0
    v_pk_mov_b32 v[60:61], 0, 0
    v_pk_mov_b32 v[62:63], 0, 0
    v_pk_mov_b32 v[64:65], 0, 0
    v_pk_mov_b32 v[66:67], 0, 0
    s_waitcnt lgkmcnt(0)
    s_barrier
    ds_read_b128 v[16:19], v11 offset:8192
    ds_read_b128 v[20:23], v11 offset:9216
    ds_read_b128 v[28:31], v10 offset:0
    ds_read_b128 v[32:35], v10 offset:1024
    ds_read_b128 v[36:39], v10 offset:2048
    ds_read_b128 v[40:43], v10 offset:3072
    ds_read_b128 v[24:27], v11 offset:10240
    s_waitcnt lgkmcnt(6)
    v_smfmac_f32_16x16x64_bf16 v[44:47], v[16:19], a[0:7], v2
    v_smfmac_f32_16x16x64_bf16 v[48:51], v[16:19], a[8:15], v2
    v_smfmac_f32_16x16x64_bf16 v[52:55], v[16:19], a[112:119], v2
    v_smfmac_f32_16x16x64_bf16 v[56:59], v[16:19], a[120:127], v2
    s_lshl_b32 s68, s44, 5
    s_add_u32 s68, s68, s70
    s_lshl_b32 s68, s68, 13
    s_lshl_b32 s22, s20, 11
    s_add_u32 s68, s68, s22
    s_add_u32 m0, s22, 139264
    s_nop 0
    buffer_load_dwordx4 v1, s[32:35], s68 offen lds
    buffer_load_dwordx4 v1, s[32:35], s68 offen offset:1024 lds
    s_cmp_lg_u32 s20, 3
    s_cbranch_scc1 PB_17
    s_lshl_b32 s61, s70, 7
    s_add_u32 s61, s61, 12288
    v_mov_b32 v13, s61
    v_mov_b32 v12, s44
    s_mov_b64 exec, 1
    buffer_store_dword v12, v13, s[64:67], 0 offen sc1
    s_mov_b64 exec, -1
PB_17:
    ds_read_b128 v[16:19], v11 offset:11264
    s_waitcnt lgkmcnt(6)
    v_smfmac_f32_16x16x64_bf16 v[44:47], v[20:23], a[16:23], v2
    v_smfmac_f32_16x16x64_bf16 v[48:51], v[20:23], a[24:31], v2
    v_smfmac_f32_16x16x64_bf16 v[52:55], v[20:23], a[128:135], v2
    v_smfmac_f32_16x16x64_bf16 v[56:59], v[20:23], a[136:143], v2
    s_add_u32 s42, s44, 1
    s_min_u32 s42, s42, 63
    s_cmp_gt_u32 s60, s42
    s_cbranch_scc1 RD_18
    v_and_b32 v69, 1, v0
    v_lshlrev_b32 v69, 12, v69
    s_lshl_b32 s61, s70, 7
    v_add_u32 v69, s61, v69
    s_mov_b32 s63, 200000
RP_19:
    buffer_load_dword v68, v69, s[64:67], 0 offen sc1
    s_waitcnt vmcnt(0)
    v_readlane_b32 s61, v68, 0
    v_readlane_b32 s62, v68, 1
    s_min_u32 s60, s61, s62
    s_cmp_gt_u32 s60, s42
    s_cbranch_scc1 RD_18
    s_sub_u32 s63, s63, 1
    s_cmp_gt_i32 s63, 0
    s_cbranch_scc1 RP_19
RD_18:
    s_lshl_b32 s71, s42, 5
    s_add_u32 s71, s71, s70
    s_lshl_b32 s71, s71, 13
    s_lshl_b32 s42, s20, 11
    s_add_u32 s71, s71, s42
    buffer_load_dwordx4 v[12:15], v1, s[36:39], s68 offen
    buffer_load_dwordx4 v[68:71], v1, s[36:39], s68 offen offset:1024
    ds_read_b128 v[20:23], v11 offset:12288
    s_waitcnt lgkmcnt(2)
    v_smfmac_f32_16x16x64_bf16 v[52:55], v[24:27], a[144:151], v2
    v_smfmac_f32_16x16x64_bf16 v[56:59], v[24:27], a[152:159], v2
    v_smfmac_f32_16x16x64_bf16 v[60:63], v[24:27], v[72:79], v2
    v_smfmac_f32_16x16x64_bf16 v[64:67], v[24:27], v[80:87], v2
    v_smfmac_f32_16x16x64_bf16 v[44:47], v[24:27], v[28:35], v2
    ds_read_b128 v[28:31], v10 offset:16384
    ds_read_b128 v[32:35], v10 offset:17408
    v_smfmac_f32_16x16x64_bf16 v[48:51], v[24:27], v[36:43], v2
    ds_read_b128 v[36:39], v10 offset:18432
    ds_read_b128 v[40:43], v10 offset:19456
    s_mov_b32 m0, 161792
    s_nop 0
    buffer_load_dwordx4 v1, s[32:35], s71 offen offset:0 sc1 lds
    ds_read_b128 v[24:27], v11 offset:13312
    s_waitcnt lgkmcnt(6)
    v_smfmac_f32_16x16x64_bf16 v[44:47], v[16:19], a[32:39], v2
    v_smfmac_f32_16x16x64_bf16 v[48:51], v[16:19], a[40:47], v2
    v_smfmac_f32_16x16x64_bf16 v[52:55], v[16:19], a[160:167], v2
    v_smfmac_f32_16x16x64_bf16 v[56:59], v[16:19], a[168:175], v2
    s_waitcnt lgkmcnt(3)
    v_smfmac_f32_16x16x64_bf16 v[60:63], v[16:19], v[28:35], v2
    ds_read_b128 v[28:31], v10 offset:4096
    ds_read_b128 v[32:35], v10 offset:5120
    s_waitcnt lgkmcnt(3)
    v_smfmac_f32_16x16x64_bf16 v[64:67], v[16:19], v[36:43], v2
    ds_read_b128 v[36:39], v10 offset:6144
    ds_read_b128 v[40:43], v10 offset:7168
    buffer_load_dwordx4 v1, s[32:35], s71 offen offset:1024 sc1 lds
    ds_read_b128 v[16:19], v11 offset:14336
    v_smfmac_f32_16x16x64_bf16 v[44:47], v[20:23], a[48:55], v2
    v_smfmac_f32_16x16x64_bf16 v[48:51], v[20:23], a[56:63], v2
    v_smfmac_f32_16x16x64_bf16 v[60:63], v[20:23], v[88:95], v2
    v_smfmac_f32_16x16x64_bf16 v[64:67], v[20:23], v[96:103], v2
    s_waitcnt lgkmcnt(3)
    v_smfmac_f32_16x16x64_bf16 v[52:55], v[20:23], v[28:35], v2
    ds_read_b128 v[28:31], v10 offset:20480
    ds_read_b128 v[32:35], v10 offset:21504
    s_waitcnt lgkmcnt(3)
    v_smfmac_f32_16x16x64_bf16 v[56:59], v[20:23], v[36:43], v2
    ds_read_b128 v[36:39], v10 offset:22528
    ds_read_b128 v[40:43], v10 offset:23552
    buffer_load_dwordx4 v1, s[36:39], s71 offen offset:0 sc1 lds
    ds_read_b128 v[20:23], v11 offset:15360
    v_smfmac_f32_16x16x64_bf16 v[44:47], v[24:27], a[64:71], v2
    v_smfmac_f32_16x16x64_bf16 v[48:51], v[24:27], a[72:79], v2
    v_smfmac_f32_16x16x64_bf16 v[52:55], v[24:27], a[176:183], v2
    v_smfmac_f32_16x16x64_bf16 v[56:59], v[24:27], a[184:191], v2
    s_waitcnt lgkmcnt(3)
    v_smfmac_f32_16x16x64_bf16 v[60:63], v[24:27], v[28:35], v2
    ds_read_b128 v[28:31], v10 offset:8192
    ds_read_b128 v[32:35], v10 offset:9216
    s_waitcnt lgkmcnt(3)
    v_smfmac_f32_16x16x64_bf16 v[64:67], v[24:27], v[36:43], v2
    ds_read_b128 v[36:39], v10 offset:10240
    ds_read_b128 v[40:43], v10 offset:11264
    buffer_load_dwordx4 v1, s[36:39], s71 offen offset:1024 sc1 lds
    ds_read_b128 v[24:27], v11 offset:16384
    v_smfmac_f32_16x16x64_bf16 v[52:55], v[16:19], a[192:199], v2
    v_smfmac_f32_16x16x64_bf16 v[56:59], v[16:19], a[200:207], v2
    v_smfmac_f32_16x16x64_bf16 v[60:63], v[16:19], v[104:111], v2
    v_smfmac_f32_16x16x64_bf16 v[64:67], v[16:19], v[112:119], v2
    s_waitcnt lgkmcnt(3)
    v_smfmac_f32_16x16x64_bf16 v[44:47], v[16:19], v[28:35], v2
    ds_read_b128 v[28:31], v10 offset:24576
    ds_read_b128 v[32:35], v10 offset:25600
    s_waitcnt lgkmcnt(3)
    v_smfmac_f32_16x16x64_bf16 v[48:51], v[16:19], v[36:43], v2
    ds_read_b128 v[36:39], v10 offset:26624
    ds_read_b128 v[40:43], v10 offset:27648
    v_smfmac_f32_16x16x64_bf16 v[44:47], v[20:23], a[80:87], v2
    v_smfmac_f32_16x16x64_bf16 v[48:51], v[20:23], a[88:95], v2
    v_smfmac_f32_16x16x64_bf16 v[52:55], v[20:23], a[208:215], v2
    v_smfmac_f32_16x16x64_bf16 v[56:59], v[20:23], a[216:223], v2
    s_waitcnt lgkmcnt(2)
    v_smfmac_f32_16x16x64_bf16 v[60:63], v[20:23], v[28:35], v2
    ds_read_b128 v[28:31], v10 offset:12288
    ds_read_b128 v[32:35], v10 offset:13312
    s_waitcnt lgkmcnt(2)
    v_smfmac_f32_16x16x64_bf16 v[64:67], v[20:23], v[36:43], v2
    ds_read_b128 v[36:39], v10 offset:14336
    ds_read_b128 v[40:43], v10 offset:15360
    v_smfmac_f32_16x16x64_bf16 v[44:47], v[24:27], a[96:103], v2
    v_smfmac_f32_16x16x64_bf16 v[48:51], v[24:27], a[104:111], v2
    v_smfmac_f32_16x16x64_bf16 v[60:63], v[24:27], v[120:127], v2
    v_smfmac_f32_16x16x64_bf16 v[64:67], v[24:27], v[128:135], v2
    s_waitcnt lgkmcnt(2)
    v_smfmac_f32_16x16x64_bf16 v[52:55], v[24:27], v[28:35], v2
    s_waitcnt lgkmcnt(0)
    v_smfmac_f32_16x16x64_bf16 v[56:59], v[24:27], v[36:43], v2
    ds_read_b128 v[28:31], v11 offset:8192
    ds_read_b128 v[32:35], v11 offset:9216
    s_nop 3
    v_permlane32_swap_b32 v44, v48
    v_permlane32_swap_b32 v45, v49
    v_permlane32_swap_b32 v46, v50
    v_permlane32_swap_b32 v47, v51
    v_permlane32_swap_b32 v52, v56
    v_permlane32_swap_b32 v53, v57
    v_permlane32_swap_b32 v54, v58
    v_permlane32_swap_b32 v55, v59
    s_waitcnt lgkmcnt(0)
    v_smfmac_f32_16x16x64_bf16 v[60:63], v[28:31], a[224:231], v2
    v_smfmac_f32_16x16x64_bf16 v[64:67], v[28:31], a[232:239], v2
    v_add_f32 v44, v44, v48
    v_add_f32 v45, v45, v49
    v_add_f32 v46, v46, v50
    v_add_f32 v47, v47, v51
    v_cvt_pk_bf16_f32 v44, v44, v45
    v_cvt_pk_bf16_f32 v45, v46, v47
    ds_write_b64 v6, v[44:45] offset:0
    v_add_f32 v52, v52, v56
    v_add_f32 v53, v53, v57
    v_add_f32 v54, v54, v58
    v_add_f32 v55, v55, v59
    v_cvt_pk_bf16_f32 v52, v52, v53
    v_cvt_pk_bf16_f32 v53, v54, v55
    ds_write_b64 v6, v[52:53] offset:2048
    v_smfmac_f32_16x16x64_bf16 v[60:63], v[32:35], a[240:247], v2
    v_smfmac_f32_16x16x64_bf16 v[64:67], v[32:35], a[248:255], v2
    s_waitcnt vmcnt(4) lgkmcnt(0)
    s_barrier
    ds_read_b64_tr_b16 v[44:45], v3 offset:0
    ds_read_b64_tr_b16 v[46:47], v3 offset:256
    ds_read_b64_tr_b16 v[16:17], v3 offset:2048
    ds_read_b64_tr_b16 v[18:19], v3 offset:2304
    ds_read_b128 v[20:23], v11 offset:0
    ds_read_b128 v[24:27], v11 offset:4096
    ds_read_b64_tr_b16 v[48:49], v3 offset:512
    ds_read_b64_tr_b16 v[50:51], v3 offset:768
    ds_read_b64_tr_b16 v[40:41], v3 offset:2560
    ds_read_b64_tr_b16 v[42:43], v3 offset:2816
    ds_read_b64_tr_b16 v[52:53], v3 offset:1024
    ds_read_b64_tr_b16 v[54:55], v3 offset:1280
    ds_read_b64_tr_b16 v[56:57], v3 offset:1536
    ds_read_b64_tr_b16 v[58:59], v3 offset:1792
    s_lshl_b32 s21, s44, 5
    s_add_u32 s21, s21, s70
    s_lshl_b32 s42, s21, 13
    s_lshl_b32 s21, s20, 10
    s_add_u32 s21, s21, s42
    s_add_u32 s21, s21, 4096
    s_nop 3
    v_cvt_pk_bf16_f32 v60, v60, v61
    v_cvt_pk_bf16_f32 v61, v62, v63
    v_cvt_pk_bf16_f32 v64, v64, v65
    v_cvt_pk_bf16_f32 v65, v66, v67
    v_lshrrev_b32 v62, 1, v1
    buffer_store_dwordx2 v[60:61], v62, s[48:51], s21 offen sc1
    buffer_store_dwordx2 v[64:65], v62, s[48:51], s21 offen offset:512 sc1
    s_waitcnt lgkmcnt(12)
    s_waitcnt lgkmcnt(10)
    v_mfma_f32_16x16x32_bf16 v[36:39], v[16:19], v[44:47], 0
    s_cmp_lg_u32 s20, 0
    s_cbranch_scc1 CK_20
    s_add_u32 s21, s42, 0
    buffer_store_dwordx4 v[16:19], v1, s[48:51], s21 offen sc1
CK_20:
    s_nop 1
    ds_read_b128 v[16:19], v11 offset:1024
    s_waitcnt lgkmcnt(10)
    v_mfma_f32_16x16x32_bf16 v[28:31], v[20:23], v[44:47], 0
    ds_read_b128 v[20:23], v11 offset:5120
    s_waitcnt lgkmcnt(10)
    v_mfma_f32_16x16x32_bf16 v[32:35], v[24:27], v[44:47], 0
    ds_read_b64_tr_b16 v[24:25], v3 offset:3072
    ds_read_b64_tr_b16 v[26:27], v3 offset:3328
    s_waitcnt lgkmcnt(10)
    s_waitcnt lgkmcnt(8)
    v_mfma_f32_16x16x32_bf16 v[36:39], v[40:43], v[48:51], v[36:39]
    s_cmp_lg_u32 s20, 1
    s_cbranch_scc1 CK_21
    s_add_u32 s21, s42, 1024
    buffer_store_dwordx4 v[40:43], v1, s[48:51], s21 offen sc1
CK_21:
    s_nop 1
    ds_read_b128 v[40:43], v11 offset:2048
    s_waitcnt lgkmcnt(4)
    v_mfma_f32_16x16x32_bf16 v[28:31], v[16:19], v[48:51], v[28:31]
    ds_read_b128 v[16:19], v11 offset:6144
    s_waitcnt lgkmcnt(4)
    v_mfma_f32_16x16x32_bf16 v[32:35], v[20:23], v[48:51], v[32:35]
    ds_read_b64_tr_b16 v[20:21], v3 offset:3584
    ds_read_b64_tr_b16 v[22:23], v3 offset:3840
    s_waitcnt lgkmcnt(4)
    v_mfma_f32_16x16x32_bf16 v[36:39], v[24:27], v[52:55], v[36:39]
    s_cmp_lg_u32 s20, 2
    s_cbranch_scc1 CK_22
    s_add_u32 s21, s42, 2048
    buffer_store_dwordx4 v[24:27], v1, s[48:51], s21 offen sc1
CK_22:
    s_nop 1
    ds_read_b128 v[24:27], v11 offset:3072
    s_waitcnt lgkmcnt(4)
    v_mfma_f32_16x16x32_bf16 v[28:31], v[40:43], v[52:55], v[28:31]
    ds_read_b128 v[40:43], v11 offset:7168
    s_waitcnt lgkmcnt(4)
    v_mfma_f32_16x16x32_bf16 v[32:35], v[16:19], v[52:55], v[32:35]
    s_waitcnt lgkmcnt(2)
    v_mfma_f32_16x16x32_bf16 v[36:39], v[20:23], v[56:59], v[36:39]
    s_cmp_lg_u32 s20, 3
    s_cbranch_scc1 CK_23
    s_add_u32 s21, s42, 3072
    buffer_store_dwordx4 v[20:23], v1, s[48:51], s21 offen sc1
CK_23:
    s_waitcnt lgkmcnt(1)
    v_mfma_f32_16x16x32_bf16 v[28:31], v[24:27], v[56:59], v[28:31]
    s_waitcnt lgkmcnt(0)
    v_mfma_f32_16x16x32_bf16 v[32:35], v[40:43], v[56:59], v[32:35]
    s_cmp_eq_u32 s44, 63
    s_cbranch_scc1 CE_15
    s_mov_b32 s21, 0x3e0293ee
    s_nop 5
    v_max3_f32 v16, v28, v29, v30
    v_max3_f32 v17, v31, v32, v33
    v_max3_f32 v18, v34, v35, v36
    v_max3_f32 v19, v37, v38, v39
    v_max3_f32 v16, v16, v17, v18
    v_max_f32 v16, v16, v19
    v_mov_b32 v17, v16
    s_nop 1
    v_permlane32_swap_b32 v16, v17
    s_nop 0
    v_max_f32 v16, v16, v17
    v_mov_b32 v17, v16
    s_nop 1
    v_permlane16_swap_b32 v16, v17
    s_nop 0
    v_max_f32 v16, v16, v17
    v_mul_f32 v16, s21, v16
    v_fma_f32 v28, v28, s21, -v16
    v_fma_f32 v29, v29, s21, -v16
    v_fma_f32 v30, v30, s21, -v16
    v_fma_f32 v31, v31, s21, -v16
    v_fma_f32 v32, v32, s21, -v16
    v_fma_f32 v33, v33, s21, -v16
    v_fma_f32 v34, v34, s21, -v16
    v_fma_f32 v35, v35, s21, -v16
    v_fma_f32 v36, v36, s21, -v16
    v_fma_f32 v37, v37, s21, -v16
    v_fma_f32 v38, v38, s21, -v16
    v_fma_f32 v39, v39, s21, -v16
    v_exp_f32 v28, v28
    v_exp_f32 v29, v29
    v_exp_f32 v30, v30
    v_exp_f32 v31, v31
    v_exp_f32 v32, v32
    v_exp_f32 v33, v33
    v_exp_f32 v34, v34
    v_exp_f32 v35, v35
    v_exp_f32 v36, v36
    v_exp_f32 v37, v37
    v_exp_f32 v38, v38
    v_exp_f32 v39, v39
    v_cvt_pk_bf16_f32 v56, v28, v29
    v_cvt_pk_bf16_f32 v57, v30, v31
    v_cvt_pk_bf16_f32 v58, v32, v33
    v_cvt_pk_bf16_f32 v59, v34, v35
    v_cvt_pk_bf16_f32 v62, v36, v37
    v_cvt_pk_bf16_f32 v63, v38, v39
    v_add_f32 v16, v36, v37
    v_add_f32 v17, v38, v39
    v_mfma_f32_16x16x32_bf16 v[44:47], v[12:15], v[56:59], 0
    v_mfma_f32_16x16x32_bf16 v[48:51], v[68:71], v[56:59], 0
    v_add_f32 v16, v16, v17
    v_add_f32 v18, v28, v29
    v_add_f32 v19, v30, v31
    v_mul_f32 v16, 0.5, v16
    v_mfma_f32_16x16x16_bf16 v[44:47], v[60:61], v[62:63], v[44:47]
    v_mfma_f32_16x16x16_bf16 v[48:51], v[64:65], v[62:63], v[48:51]
    v_add_f32 v17, v32, v33
    v_add_f32 v20, v34, v35
    v_add_f32 v18, v18, v19
    v_add_f32 v17, v17, v20
    v_add_f32 v16, v16, v18
    v_add_f32 v16, v16, v17
    ds_read_b128 v[28:31], v10 offset:28672
    ds_read_b128 v[32:35], v10 offset:29696
    ds_read_b128 v[36:39], v10 offset:30720
    ds_read_b128 v[40:43], v10 offset:31744
    v_mov_b32 v17, v16
    s_nop 1
    v_permlane32_swap_b32 v16, v17
    s_nop 0
    v_add_f32 v16, v16, v17
    v_mov_b32 v17, v16
    s_nop 1
    v_permlane16_swap_b32 v16, v17
    s_nop 0
    v_add_f32 v16, v16, v17
    v_rcp_f32 v16, v16
    s_nop 1
    v_mul_f32 v44, v44, v16
    v_mul_f32 v45, v45, v16
    v_mul_f32 v46, v46, v16
    v_mul_f32 v47, v47, v16
    v_mul_f32 v48, v48, v16
    v_mul_f32 v49, v49, v16
    v_mul_f32 v50, v50, v16
    v_mul_f32 v51, v51, v16
    v_cvt_pk_bf16_f32 v44, v44, v45
    v_cvt_pk_bf16_f32 v45, v46, v47
    ds_write_b64 v4, v[44:45] offset:0
    v_cvt_pk_bf16_f32 v48, v48, v49
    v_cvt_pk_bf16_f32 v49, v50, v51
    ds_write_b64 v4, v[48:49] offset:32
    v_pk_mov_b32 v[46:47], 0, 0
    v_pk_mov_b32 v[50:51], 0, 0
    v_pk_mov_b32 v[52:53], 0, 0
    v_pk_mov_b32 v[54:55], 0, 0
    v_pk_mov_b32 v[56:57], 0, 0
    v_pk_mov_b32 v[58:59], 0, 0
    v_pk_mov_b32 v[60:61], 0, 0
    v_pk_mov_b32 v[62:63], 0, 0
    v_pk_mov_b32 v[64:65], 0, 0
    v_pk_mov_b32 v[66:67], 0, 0
    v_pk_mov_b32 v[12:13], 0, 0
    v_pk_mov_b32 v[14:15], 0, 0
    v_pk_mov_b32 v[68:69], 0, 0
    v_pk_mov_b32 v[70:71], 0, 0
    v_pk_mov_b32 v[24:25], 0, 0
    v_pk_mov_b32 v[26:27], 0, 0
    s_waitcnt lgkmcnt(0)
    v_pk_mov_b32 v[44:45], 0, 0
    v_pk_mov_b32 v[48:49], 0, 0
    s_barrier
    ds_read_b128 v[16:19], v5
    ds_read_b128 v[20:23], v5 offset:128
    s_lshr_b32 s21, s44, 1
    s_and_b32 s45, s21, 1
    s_and_b32 s21, s44, 1
    s_mul_i32 s76, s21, 294912
    s_waitcnt lgkmcnt(0)
    v_smfmac_f32_16x16x64_bf16 v[12:15], v[20:23], v[28:35], v2
    v_smfmac_f32_16x16x64_bf16 v[68:71], v[20:23], v[36:43], v2
    v_smfmac_f32_16x16x64_bf16 v[12:15], v[16:19], v[184:191], v2
    v_smfmac_f32_16x16x64_bf16 v[68:71], v[16:19], v[192:199], v2
    ds_read_b128 v[28:31], v10 offset:32768
    ds_read_b128 v[32:35], v10 offset:33792
    v_smfmac_f32_16x16x64_bf16 v[60:63], v[16:19], v[168:175], v2
    v_smfmac_f32_16x16x64_bf16 v[64:67], v[16:19], v[176:183], v2
    v_smfmac_f32_16x16x64_bf16 v[60:63], v[20:23], v[240:247], v2
    v_smfmac_f32_16x16x64_bf16 v[64:67], v[20:23], v[248:255], v2
    v_smfmac_f32_16x16x64_bf16 v[24:27], v[16:19], v[200:207], v2
    s_waitcnt lgkmcnt(0)
    v_smfmac_f32_16x16x64_bf16 v[24:27], v[20:23], v[28:35], v2
    v_smfmac_f32_16x16x64_bf16 v[44:47], v[16:19], v[136:143], v2
    v_smfmac_f32_16x16x64_bf16 v[48:51], v[16:19], v[144:151], v2
    v_permlane32_swap_b32 v60, v64
    v_permlane32_swap_b32 v61, v65
    v_permlane32_swap_b32 v62, v66
    v_permlane32_swap_b32 v63, v67
    v_permlane32_swap_b32 v12, v68
    v_permlane32_swap_b32 v13, v69
    v_permlane32_swap_b32 v14, v70
    v_permlane32_swap_b32 v15, v71
    v_smfmac_f32_16x16x64_bf16 v[44:47], v[20:23], v[208:215], v2
    v_smfmac_f32_16x16x64_bf16 v[48:51], v[20:23], v[216:223], v2
    v_add_f32 v60, v60, v64
    v_add_f32 v61, v61, v65
    v_add_f32 v62, v62, v66
    v_add_f32 v63, v63, v67
    v_cvt_pk_bf16_f32 v36, v60, v61
    v_cvt_pk_bf16_f32 v37, v62, v63
    v_add_f32 v12, v12, v68
    v_add_f32 v13, v13, v69
    v_add_f32 v14, v14, v70
    v_add_f32 v15, v15, v71
    v_cvt_pk_bf16_f32 v38, v12, v13
    v_cvt_pk_bf16_f32 v39, v14, v15
    v_smfmac_f32_16x16x64_bf16 v[52:55], v[16:19], v[152:159], v2
    v_smfmac_f32_16x16x64_bf16 v[56:59], v[16:19], v[160:167], v2
    v_permlane16_swap_b32 v36, v38
    v_permlane16_swap_b32 v37, v39
    s_add_u32 s21, s76, 1024
    s_nop 0
    v_and_or_b32 v36, v36, -2, s45
    buffer_store_dwordx4 v[36:39], v7, s[28:31], s21 offen
    v_mov_b32 v28, v24
    v_mov_b32 v29, v25
    v_mov_b32 v30, v26
    v_mov_b32 v31, v27
    v_smfmac_f32_16x16x64_bf16 v[52:55], v[20:23], v[224:231], v2
    v_permlane32_swap_b32 v24, v28
    v_permlane32_swap_b32 v25, v29
    v_permlane32_swap_b32 v26, v30
    v_permlane32_swap_b32 v27, v31
    v_smfmac_f32_16x16x64_bf16 v[56:59], v[20:23], v[232:239], v2
    v_add_f32 v24, v24, v28
    v_add_f32 v25, v25, v29
    v_add_f32 v26, v26, v30
    v_add_f32 v27, v27, v31
    v_cvt_pk_bf16_f32 v32, v24, v25
    v_cvt_pk_bf16_f32 v33, v26, v27
    v_mov_b32 v34, v32
    v_mov_b32 v35, v33
    v_permlane32_swap_b32 v44, v48
    v_permlane32_swap_b32 v45, v49
    v_permlane32_swap_b32 v46, v50
    v_permlane32_swap_b32 v47, v51
    v_permlane16_swap_b32 v32, v34
    v_permlane16_swap_b32 v33, v35
    s_add_u32 s21, s76, 2048
    v_add_f32 v44, v44, v48
    v_add_f32 v45, v45, v49
    v_add_f32 v46, v46, v50
    v_add_f32 v47, v47, v51
    v_cvt_pk_bf16_f32 v40, v44, v45
    v_cvt_pk_bf16_f32 v41, v46, v47
    v_and_or_b32 v32, v32, -2, s45
    s_mov_b64 exec, 0xffff
    buffer_store_dwordx4 v[32:35], v7, s[28:31], s21 offen
    s_mov_b64 exec, -1
    s_nop 1
    v_permlane32_swap_b32 v52, v56
    v_permlane32_swap_b32 v53, v57
    v_permlane32_swap_b32 v54, v58
    v_permlane32_swap_b32 v55, v59
    s_nop 0
    v_add_f32 v52, v52, v56
    v_add_f32 v53, v53, v57
    v_add_f32 v54, v54, v58
    v_add_f32 v55, v55, v59
    v_cvt_pk_bf16_f32 v42, v52, v53
    v_cvt_pk_bf16_f32 v43, v54, v55
    s_nop 0
    v_permlane16_swap_b32 v40, v42
    v_permlane16_swap_b32 v41, v43
    s_add_u32 s21, s76, 0
    s_nop 0
    v_and_or_b32 v40, v40, -2, s45
    buffer_store_dwordx4 v[40:43], v7, s[28:31], s21 offen
    s_add_u32 s44, s44, 1
    s_cmp_ge_u32 s41, 72
    s_cbranch_scc1 CR_24
    ds_read_b128 v[44:47], v11 offset:21504
    s_add_u32 s21, s76, 0
    buffer_load_dwordx4 v[48:51], v8, s[28:31], s21 offen sc1
    s_add_u32 s21, s76, 73728
    buffer_load_dwordx4 v[52:55], v8, s[28:31], s21 offen sc1
    s_add_u32 s21, s76, 147456
    buffer_load_dwordx4 v[56:59], v8, s[28:31], s21 offen sc1
    s_add_u32 s21, s76, 221184
    buffer_load_dwordx4 v[60:63], v8, s[28:31], s21 offen sc1
    s_sleep 3
    s_add_u32 s21, s76, 0
    buffer_load_dwordx4 v[28:31], v8, s[28:31], s21 offen sc1
    s_add_u32 s21, s76, 73728
    buffer_load_dwordx4 v[32:35], v8, s[28:31], s21 offen sc1
    s_add_u32 s21, s76, 147456
    buffer_load_dwordx4 v[36:39], v8, s[28:31], s21 offen sc1
    s_add_u32 s21, s76, 221184
    buffer_load_dwordx4 v[40:43], v8, s[28:31], s21 offen sc1
CQ_25:
    s_waitcnt vmcnt(4)
    v_xor_b32 v16, s45, v48
    v_xor_b32 v17, s45, v52
    v_xor_b32 v18, s45, v56
    v_xor_b32 v19, s45, v60
    v_or3_b32 v16, v16, v17, v18
    v_or_b32 v16, v16, v19
    v_and_b32 v16, 1, v16
    v_cmp_ne_u32 vcc, 0, v16
    s_cbranch_vccz CQA_26
    s_add_u32 s21, s76, 0
    buffer_load_dwordx4 v[48:51], v8, s[28:31], s21 offen sc1
    s_add_u32 s21, s76, 73728
    buffer_load_dwordx4 v[52:55], v8, s[28:31], s21 offen sc1
    s_add_u32 s21, s76, 147456
    buffer_load_dwordx4 v[56:59], v8, s[28:31], s21 offen sc1
    s_add_u32 s21, s76, 221184
    buffer_load_dwordx4 v[60:63], v8, s[28:31], s21 offen sc1
    s_waitcnt vmcnt(4)
    v_xor_b32 v16, s45, v28
    v_xor_b32 v17, s45, v32
    v_xor_b32 v18, s45, v36
    v_xor_b32 v19, s45, v40
    v_or3_b32 v16, v16, v17, v18
    v_or_b32 v16, v16, v19
    v_and_b32 v16, 1, v16
    v_cmp_ne_u32 vcc, 0, v16
    s_cbranch_vccz CQB_27
    s_add_u32 s21, s76, 0
    buffer_load_dwordx4 v[28:31], v8, s[28:31], s21 offen sc1
    s_add_u32 s21, s76, 73728
    buffer_load_dwordx4 v[32:35], v8, s[28:31], s21 offen sc1
    s_add_u32 s21, s76, 147456
    buffer_load_dwordx4 v[36:39], v8, s[28:31], s21 offen sc1
    s_add_u32 s21, s76, 221184
    buffer_load_dwordx4 v[40:43], v8, s[28:31], s21 offen sc1
    s_sub_u32 s46, s46, 1
    s_cmp_gt_i32 s46, 0
    s_cbranch_scc1 CQ_25
CQA_26:
    s_waitcnt lgkmcnt(0)
    v_mfma_f32_16x16x32_bf16 v[64:67], v[48:51], v[44:47], 0
    v_mfma_f32_16x16x32_bf16 v[20:23], v[52:55], v[44:47], 0
    v_mfma_f32_16x16x32_bf16 v[64:67], v[56:59], v[44:47], v[64:67]
    v_mfma_f32_16x16x32_bf16 v[20:23], v[60:63], v[44:47], v[20:23]
    s_branch CQJ_28
CQB_27:
    s_waitcnt lgkmcnt(0)
    v_mfma_f32_16x16x32_bf16 v[64:67], v[28:31], v[44:47], 0
    v_mfma_f32_16x16x32_bf16 v[20:23], v[32:35], v[44:47], 0
    v_mfma_f32_16x16x32_bf16 v[64:67], v[36:39], v[44:47], v[64:67]
    v_mfma_f32_16x16x32_bf16 v[20:23], v[40:43], v[44:47], v[20:23]
CQJ_28:
    s_sub_u32 s21, s44, 1
    s_and_b32 s21, s21, 1
    s_lshl_b32 s21, s21, 14
    s_add_u32 s21, s21, 1048576
    s_nop 5
    v_add_f32 v64, v64, v20
    v_add_f32 v65, v65, v21
    v_add_f32 v66, v66, v22
    v_add_f32 v67, v67, v23
    v_mov_b32 v16, v64
    v_mov_b32 v17, v65
    v_mov_b32 v18, v66
    v_mov_b32 v19, v67
    s_nop 0
    v_permlane32_swap_b32 v64, v16
    v_permlane32_swap_b32 v65, v17
    v_permlane32_swap_b32 v66, v18
    v_permlane32_swap_b32 v67, v19
    s_nop 0
    v_add_f32 v64, v64, v16
    v_add_f32 v65, v65, v17
    v_add_f32 v66, v66, v18
    v_add_f32 v67, v67, v19
    v_cvt_pk_bf16_f32 v16, v64, v65
    v_cvt_pk_bf16_f32 v17, v66, v67
    v_mov_b32 v18, v16
    v_mov_b32 v19, v17
    s_nop 1
    v_permlane16_swap_b32 v16, v18
    v_permlane16_swap_b32 v17, v19
    s_nop 0
    v_and_or_b32 v16, v16, -2, s45
    s_mov_b64 exec, 0xff
    buffer_store_dwordx4 v[16:19], v9, s[28:31], s21 offen
    s_mov_b64 exec, -1
CR_24:
    s_branch CL_14
CE_15:
    s_waitcnt vmcnt(0)
    s_barrier
    s_mov_b32 s44, 64
    s_cmp_lg_u32 s20, 3
    s_cbranch_scc1 PB_29
    s_lshl_b32 s61, s70, 7
    s_add_u32 s61, s61, 12288
    v_mov_b32 v17, s61
    v_mov_b32 v16, s44
    s_mov_b64 exec, 1
    buffer_store_dword v16, v17, s[64:67], 0 offen sc1
    s_mov_b64 exec, -1
PB_29:
    s_waitcnt vmcnt(0)
    s_branch M_END
M_WORK:
    v_accvgpr_read_b32 v0, a255
    s_nop 0
    v_lshrrev_b32 v1, 6, v0
    v_and_b32 v0, 63, v0
    s_nop 0
    v_readfirstlane_b32 s20, v1
    s_barrier
    s_load_dwordx4 s[4:7], s[0:1], 136
    s_cmp_lg_u32 s20, 0
    s_cbranch_scc1 M_TK
    s_waitcnt lgkmcnt(0)
    s_mov_b32 s8, s4
    s_mov_b32 s9, s5
    s_mov_b32 s10, 256
    s_mov_b32 s11, 0x00020000
    v_mov_b32 v2, 36
    v_mov_b32 v3, 1
    s_mov_b64 exec, 1
    buffer_atomic_add v3, v2, s[8:11], 0 offen sc0 sc1
    s_waitcnt vmcnt(0)
    v_mov_b32 v2, 0
    ds_write_b32 v2, v3
    s_mov_b64 exec, -1
M_TK:
    s_waitcnt lgkmcnt(0)
    s_barrier
    v_mov_b32 v2, 0
    ds_read_b32 v3, v2
    s_waitcnt lgkmcnt(0)
    v_readfirstlane_b32 s39, v3
    s_barrier
    s_add_u32 s32, s6, 92274688
    s_addc_u32 s33, s7, 0
    s_mov_b32 s34, 20480
    s_mov_b32 s35, 0x00020000
    s_cmp_ge_u32 s39, 96
    s_cbranch_scc1 M_D1
    s_and_b32 s40, s39, 1
    s_lshr_b32 s41, s39, 1
    s_mov_b32 s42, 0
    s_cmp_lt_u32 s39, 64
    s_cbranch_scc1 M_QKV
    s_mov_b32 s40, 2
    s_sub_u32 s41, s39, 64
M_QKV:
    v_accvgpr_read_b32 v0, a255
    s_nop 0
    v_lshrrev_b32 v1, 6, v0
    v_and_b32 v2, 63, v0
    s_nop 0
    v_readfirstlane_b32 s20, v1
    s_mov_b32 s21, 24
    s_cmp_eq_u32 s40, 1
    s_cselect_b32 s21, 32, s21
    s_cmp_eq_u32 s40, 2
    s_cselect_b32 s21, 16, s21
    s_load_dwordx2 s[4:5], s[0:1], s21
    s_load_dwordx2 s[6:7], s[0:1], 0
    s_load_dwordx2 s[22:23], s[0:1], 144
    s_waitcnt lgkmcnt(0)
    s_mov_b32 s8, s4
    s_mov_b32 s9, s5
    s_mov_b32 s10, 4718592
    s_mov_b32 s11, 0x00020000
    s_mov_b32 s12, s6
    s_mov_b32 s13, s7
    s_mov_b32 s14, 2359296
    s_mov_b32 s15, 0x00020000
    s_add_u32 s44, s22, 92274688
    s_addc_u32 s45, s23, 0
    s_mov_b32 s46, 20480
    s_mov_b32 s47, 0x00020000
    s_lshl_b32 s21, s40, 12
    s_lshl_b32 s24, s41, 7
    s_add_u32 s21, s21, s24
    v_mov_b32 v1, s21
    s_mov_b32 s21, 16777216
    s_cmp_eq_u32 s40, 1
    s_cselect_b32 s21, 33554432, s21
    s_cmp_eq_u32 s40, 2
    s_cselect_b32 s21, 0, s21
    s_add_u32 s16, s22, s21
    s_addc_u32 s17, s23, 0
    s_mov_b32 s18, 16777216
    s_mov_b32 s19, 0x00020000
    v_lshrrev_b32 v4, 1, v2
    v_and_b32 v4, 15, v4
    v_lshrrev_b32 v5, 2, v4
    v_and_b32 v4, 3, v4
    v_lshl_add_u32 v4, v5, 3, v4
    v_lshlrev_b32 v3, 13, v4
    v_lshrrev_b32 v4, 5, v2
    v_lshl_add_u32 v3, v4, 5, v3
    v_and_b32 v4, 1, v2
    v_lshl_add_u32 v3, v4, 4, v3
    s_lshl_b32 s21, s41, 8
    s_lshl_b32 s24, s20, 6
    s_add_u32 s21, s21, s24
    v_add_u32 v3, s21, v3
    s_mul_i32 s25, s20, 36864
    s_add_u32 m0, s25, 0
    s_mov_b32 s21, 0
    buffer_load_dwordx4 v3, s[8:11], s21 offen lds
    s_add_u32 m0, s25, 1024
    s_mov_b32 s21, 32768
    buffer_load_dwordx4 v3, s[8:11], s21 offen lds
    s_add_u32 m0, s25, 2048
    s_mov_b32 s21, 262144
    buffer_load_dwordx4 v3, s[8:11], s21 offen lds
    s_add_u32 m0, s25, 3072
    s_mov_b32 s21, 294912
    buffer_load_dwordx4 v3, s[8:11], s21 offen lds
    s_add_u32 m0, s25, 4096
    s_mov_b32 s21, 524288
    buffer_load_dwordx4 v3, s[8:11], s21 offen lds
    s_add_u32 m0, s25, 5120
    s_mov_b32 s21, 557056
    buffer_load_dwordx4 v3, s[8:11], s21 offen lds
    s_add_u32 m0, s25, 6144
    s_mov_b32 s21, 786432
    buffer_load_dwordx4 v3, s[8:11], s21 offen lds
    s_add_u32 m0, s25, 7168
    s_mov_b32 s21, 819200
    buffer_load_dwordx4 v3, s[8:11], s21 offen lds
    s_add_u32 m0, s25, 8192
    s_mov_b32 s21, 1048576
    buffer_load_dwordx4 v3, s[8:11], s21 offen lds
    s_add_u32 m0, s25, 9216
    s_mov_b32 s21, 1081344
    buffer_load_dwordx4 v3, s[8:11], s21 offen lds
    s_add_u32 m0, s25, 10240
    s_mov_b32 s21, 1310720
    buffer_load_dwordx4 v3, s[8:11], s21 offen lds
    s_add_u32 m0, s25, 11264
    s_mov_b32 s21, 1343488
    buffer_load_dwordx4 v3, s[8:11], s21 offen lds
    s_add_u32 m0, s25, 12288
    s_mov_b32 s21, 1572864
    buffer_load_dwordx4 v3, s[8:11], s21 offen lds
    s_add_u32 m0, s25, 13312
    s_mov_b32 s21, 1605632
    buffer_load_dwordx4 v3, s[8:11], s21 offen lds
    s_add_u32 m0, s25, 14336
    s_mov_b32 s21, 1835008
    buffer_load_dwordx4 v3, s[8:11], s21 offen lds
    s_add_u32 m0, s25, 15360
    s_mov_b32 s21, 1867776
    buffer_load_dwordx4 v3, s[8:11], s21 offen lds
    s_add_u32 m0, s25, 16384
    s_mov_b32 s21, 2097152
    buffer_load_dwordx4 v3, s[8:11], s21 offen lds
    s_add_u32 m0, s25, 17408
    s_mov_b32 s21, 2129920
    buffer_load_dwordx4 v3, s[8:11], s21 offen lds
    s_add_u32 m0, s25, 18432
    s_mov_b32 s21, 2359296
    buffer_load_dwordx4 v3, s[8:11], s21 offen lds
    s_add_u32 m0, s25, 19456
    s_mov_b32 s21, 2392064
    buffer_load_dwordx4 v3, s[8:11], s21 offen lds
    s_add_u32 m0, s25, 20480
    s_mov_b32 s21, 2621440
    buffer_load_dwordx4 v3, s[8:11], s21 offen lds
    s_add_u32 m0, s25, 21504
    s_mov_b32 s21, 2654208
    buffer_load_dwordx4 v3, s[8:11], s21 offen lds
    s_add_u32 m0, s25, 22528
    s_mov_b32 s21, 2883584
    buffer_load_dwordx4 v3, s[8:11], s21 offen lds
    s_add_u32 m0, s25, 23552
    s_mov_b32 s21, 2916352
    buffer_load_dwordx4 v3, s[8:11], s21 offen lds
    s_add_u32 m0, s25, 24576
    s_mov_b32 s21, 3145728
    buffer_load_dwordx4 v3, s[8:11], s21 offen lds
    s_add_u32 m0, s25, 25600
    s_mov_b32 s21, 3178496
    buffer_load_dwordx4 v3, s[8:11], s21 offen lds
    s_add_u32 m0, s25, 26624
    s_mov_b32 s21, 3407872
    buffer_load_dwordx4 v3, s[8:11], s21 offen lds
    s_add_u32 m0, s25, 27648
    s_mov_b32 s21, 3440640
    buffer_load_dwordx4 v3, s[8:11], s21 offen lds
    s_add_u32 m0, s25, 28672
    s_mov_b32 s21, 3670016
    buffer_load_dwordx4 v3, s[8:11], s21 offen lds
    s_add_u32 m0, s25, 29696
    s_mov_b32 s21, 3702784
    buffer_load_dwordx4 v3, s[8:11], s21 offen lds
    s_add_u32 m0, s25, 30720
    s_mov_b32 s21, 3932160
    buffer_load_dwordx4 v3, s[8:11], s21 offen lds
    s_add_u32 m0, s25, 31744
    s_mov_b32 s21, 3964928
    buffer_load_dwordx4 v3, s[8:11], s21 offen lds
    s_add_u32 m0, s25, 32768
    s_mov_b32 s21, 4194304
    buffer_load_dwordx4 v3, s[8:11], s21 offen lds
    s_add_u32 m0, s25, 33792
    s_mov_b32 s21, 4227072
    buffer_load_dwordx4 v3, s[8:11], s21 offen lds
    s_add_u32 m0, s25, 34816
    s_mov_b32 s21, 4456448
    buffer_load_dwordx4 v3, s[8:11], s21 offen lds
    s_add_u32 m0, s25, 35840
    s_mov_b32 s21, 4489216
    buffer_load_dwordx4 v3, s[8:11], s21 offen lds
    v_lshrrev_b32 v4, 3, v2
    v_and_b32 v5, 7, v2
    v_xor_b32 v5, v5, v4
    s_and_b32 s24, s20, 1
    v_xor_b32 v5, s24, v5
    v_lshlrev_b32 v5, 4, v5
    v_mul_u32_u24 v4, 1152, v4
    v_add_u32 v5, v5, v4
    s_mul_i32 s21, s20, 9216
    v_add_u32 v5, s21, v5
    v_and_b32 v4, 7, v2
    v_bfe_u32 v11, v2, 3, 1
    v_lshrrev_b32 v12, 4, v2
    v_xor_b32 v12, v12, v4
    v_xor_b32 v12, v12, v11
    v_lshlrev_b32 v12, 4, v12
    v_lshl_add_u32 v12, v4, 7, v12
    v_mul_u32_u24 v11, 9216, v11
    v_add_u32 v11, v11, v12
    v_xor_b32 v12, 64, v11
    v_lshlrev_b32 v6, 3, v2
    v_add_u32 v6, s25, v6
    v_lshlrev_b32 v7, 4, v2
    s_waitcnt vmcnt(0)
    ds_read_b64_tr_b16 v[64:65], v6 offset:0
    ds_read_b64_tr_b16 v[136:137], v6 offset:512
    ds_read_b64_tr_b16 v[66:67], v6 offset:1024
    ds_read_b64_tr_b16 v[138:139], v6 offset:1536
    ds_read_b64_tr_b16 v[68:69], v6 offset:2048
    ds_read_b64_tr_b16 v[140:141], v6 offset:2560
    ds_read_b64_tr_b16 v[70:71], v6 offset:3072
    ds_read_b64_tr_b16 v[142:143], v6 offset:3584
    ds_read_b64_tr_b16 v[72:73], v6 offset:4096
    ds_read_b64_tr_b16 v[144:145], v6 offset:4608
    ds_read_b64_tr_b16 v[74:75], v6 offset:5120
    ds_read_b64_tr_b16 v[146:147], v6 offset:5632
    ds_read_b64_tr_b16 v[76:77], v6 offset:6144
    ds_read_b64_tr_b16 v[148:149], v6 offset:6656
    ds_read_b64_tr_b16 v[78:79], v6 offset:7168
    ds_read_b64_tr_b16 v[150:151], v6 offset:7680
    s_waitcnt lgkmcnt(0)
    ds_read_b64_tr_b16 v[80:81], v6 offset:8192
    ds_read_b64_tr_b16 v[152:153], v6 offset:8704
    ds_read_b64_tr_b16 v[82:83], v6 offset:9216
    ds_read_b64_tr_b16 v[154:155], v6 offset:9728
    ds_read_b64_tr_b16 v[84:85], v6 offset:10240
    ds_read_b64_tr_b16 v[156:157], v6 offset:10752
    ds_read_b64_tr_b16 v[86:87], v6 offset:11264
    ds_read_b64_tr_b16 v[158:159], v6 offset:11776
    ds_read_b64_tr_b16 v[88:89], v6 offset:12288
    ds_read_b64_tr_b16 v[160:161], v6 offset:12800
    ds_read_b64_tr_b16 v[90:91], v6 offset:13312
    ds_read_b64_tr_b16 v[162:163], v6 offset:13824
    ds_read_b64_tr_b16 v[92:93], v6 offset:14336
    ds_read_b64_tr_b16 v[164:165], v6 offset:14848
    ds_read_b64_tr_b16 v[94:95], v6 offset:15360
    ds_read_b64_tr_b16 v[166:167], v6 offset:15872
    s_waitcnt lgkmcnt(0)
    ds_read_b64_tr_b16 v[96:97], v6 offset:16384
    ds_read_b64_tr_b16 v[168:169], v6 offset:16896
    ds_read_b64_tr_b16 v[98:99], v6 offset:17408
    ds_read_b64_tr_b16 v[170:171], v6 offset:17920
    ds_read_b64_tr_b16 v[100:101], v6 offset:18432
    ds_read_b64_tr_b16 v[172:173], v6 offset:18944
    ds_read_b64_tr_b16 v[102:103], v6 offset:19456
    ds_read_b64_tr_b16 v[174:175], v6 offset:19968
    ds_read_b64_tr_b16 v[104:105], v6 offset:20480
    ds_read_b64_tr_b16 v[176:177], v6 offset:20992
    ds_read_b64_tr_b16 v[106:107], v6 offset:21504
    ds_read_b64_tr_b16 v[178:179], v6 offset:22016
    ds_read_b64_tr_b16 v[108:109], v6 offset:22528
    ds_read_b64_tr_b16 v[180:181], v6 offset:23040
    ds_read_b64_tr_b16 v[110:111], v6 offset:23552
    ds_read_b64_tr_b16 v[182:183], v6 offset:24064
    s_waitcnt lgkmcnt(0)
    ds_read_b64_tr_b16 v[112:113], v6 offset:24576
    ds_read_b64_tr_b16 v[184:185], v6 offset:25088
    ds_read_b64_tr_b16 v[114:115], v6 offset:25600
    ds_read_b64_tr_b16 v[186:187], v6 offset:26112
    ds_read_b64_tr_b16 v[116:117], v6 offset:26624
    ds_read_b64_tr_b16 v[188:189], v6 offset:27136
    ds_read_b64_tr_b16 v[118:119], v6 offset:27648
    ds_read_b64_tr_b16 v[190:191], v6 offset:28160
    ds_read_b64_tr_b16 v[120:121], v6 offset:28672
    ds_read_b64_tr_b16 v[192:193], v6 offset:29184
    ds_read_b64_tr_b16 v[122:123], v6 offset:29696
    ds_read_b64_tr_b16 v[194:195], v6 offset:30208
    ds_read_b64_tr_b16 v[124:125], v6 offset:30720
    ds_read_b64_tr_b16 v[196:197], v6 offset:31232
    ds_read_b64_tr_b16 v[126:127], v6 offset:31744
    ds_read_b64_tr_b16 v[198:199], v6 offset:32256
    s_waitcnt lgkmcnt(0)
    ds_read_b64_tr_b16 v[128:129], v6 offset:32768
    ds_read_b64_tr_b16 v[200:201], v6 offset:33280
    ds_read_b64_tr_b16 v[130:131], v6 offset:33792
    ds_read_b64_tr_b16 v[202:203], v6 offset:34304
    ds_read_b64_tr_b16 v[132:133], v6 offset:34816
    ds_read_b64_tr_b16 v[204:205], v6 offset:35328
    ds_read_b64_tr_b16 v[134:135], v6 offset:35840
    ds_read_b64_tr_b16 v[206:207], v6 offset:36352
    s_waitcnt lgkmcnt(0)
    s_barrier
    v_mov_b32 v240, v5
    v_mov_b32 v241, v6
    v_mov_b32 v242, v7
    s_cmp_eq_u32 s98, 1
    s_cbranch_scc1 GT_31
    s_load_dwordx2 s[4:5], s[0:1], 136
    s_waitcnt lgkmcnt(0)
    s_mov_b32 s28, s4
    s_mov_b32 s29, s5
    s_mov_b32 s30, 256
    s_mov_b32 s31, 0x00020000
    v_mov_b32 v5, 64
    v_mov_b32 v7, 32
    s_mov_b32 s38, 40000
PL_32:
    buffer_load_dword v6, v5, s[28:31], 0 offen sc1
    s_waitcnt vmcnt(0)
    v_cmp_gt_u32 vcc, v7, v6
    s_cmp_eq_u64 vcc, 0
    s_cbranch_scc1 PK_33
    s_sleep 6
    s_sub_u32 s38, s38, 1
    s_cmp_gt_i32 s38, 0
    s_cbranch_scc1 PL_32
PK_33:
GT_31:
    v_mov_b32 v5, v240
    v_mov_b32 v6, v241
    v_mov_b32 v7, v242
    s_mul_i32 s26, s20, 9216
    s_add_u32 s29, s42, 63
    s_mov_b32 s27, s42
    s_mov_b32 s28, 0
    s_min_u32 s30, s27, s29
    s_mul_i32 s30, s30, 36864
    s_add_u32 s31, s26, s28
    s_add_u32 m0, s31, 0
    s_nop 0
    buffer_load_dwordx4 v5, s[12:15], s30 offen offset:0 lds
    s_add_u32 m0, s31, 896
    s_nop 0
    buffer_load_dwordx4 v5, s[12:15], s30 offen offset:128 lds
    s_add_u32 m0, s31, 1792
    s_nop 0
    buffer_load_dwordx4 v5, s[12:15], s30 offen offset:256 lds
    s_add_u32 m0, s31, 2688
    s_nop 0
    buffer_load_dwordx4 v5, s[12:15], s30 offen offset:384 lds
    s_add_u32 m0, s31, 3584
    s_nop 0
    buffer_load_dwordx4 v5, s[12:15], s30 offen offset:512 lds
    s_add_u32 m0, s31, 4480
    s_nop 0
    buffer_load_dwordx4 v5, s[12:15], s30 offen offset:640 lds
    s_add_u32 m0, s31, 5376
    s_nop 0
    buffer_load_dwordx4 v5, s[12:15], s30 offen offset:768 lds
    s_add_u32 m0, s31, 6272
    s_nop 0
    buffer_load_dwordx4 v5, s[12:15], s30 offen offset:896 lds
    s_add_u32 m0, s31, 7168
    s_nop 0
    buffer_load_dwordx4 v5, s[12:15], s30 offen offset:1024 lds
    s_add_u32 s27, s27, 1
    s_add_u32 s28, s28, 36864
    s_min_u32 s30, s27, s29
    s_mul_i32 s30, s30, 36864
    s_add_u32 s31, s26, s28
    s_add_u32 m0, s31, 0
    s_nop 0
    buffer_load_dwordx4 v5, s[12:15], s30 offen offset:0 lds
    s_add_u32 m0, s31, 896
    s_nop 0
    buffer_load_dwordx4 v5, s[12:15], s30 offen offset:128 lds
    s_add_u32 m0, s31, 1792
    s_nop 0
    buffer_load_dwordx4 v5, s[12:15], s30 offen offset:256 lds
    s_add_u32 m0, s31, 2688
    s_nop 0
    buffer_load_dwordx4 v5, s[12:15], s30 offen offset:384 lds
    s_add_u32 m0, s31, 3584
    s_nop 0
    buffer_load_dwordx4 v5, s[12:15], s30 offen offset:512 lds
    s_add_u32 m0, s31, 4480
    s_nop 0
    buffer_load_dwordx4 v5, s[12:15], s30 offen offset:640 lds
    s_add_u32 m0, s31, 5376
    s_nop 0
    buffer_load_dwordx4 v5, s[12:15], s30 offen offset:768 lds
    s_add_u32 m0, s31, 6272
    s_nop 0
    buffer_load_dwordx4 v5, s[12:15], s30 offen offset:896 lds
    s_add_u32 m0, s31, 7168
    s_nop 0
    buffer_load_dwordx4 v5, s[12:15], s30 offen offset:1024 lds
    s_add_u32 s27, s27, 1
    s_add_u32 s28, s28, 36864
    s_min_u32 s30, s27, s29
    s_mul_i32 s30, s30, 36864
    s_add_u32 s31, s26, s28
    s_add_u32 m0, s31, 0
    s_nop 0
    buffer_load_dwordx4 v5, s[12:15], s30 offen offset:0 lds
    s_add_u32 m0, s31, 896
    s_nop 0
    buffer_load_dwordx4 v5, s[12:15], s30 offen offset:128 lds
    s_add_u32 m0, s31, 1792
    s_nop 0
    buffer_load_dwordx4 v5, s[12:15], s30 offen offset:256 lds
    s_add_u32 m0, s31, 2688
    s_nop 0
    buffer_load_dwordx4 v5, s[12:15], s30 offen offset:384 lds
    s_add_u32 m0, s31, 3584
    s_nop 0
    buffer_load_dwordx4 v5, s[12:15], s30 offen offset:512 lds
    s_add_u32 m0, s31, 4480
    s_nop 0
    buffer_load_dwordx4 v5, s[12:15], s30 offen offset:640 lds
    s_add_u32 m0, s31, 5376
    s_nop 0
    buffer_load_dwordx4 v5, s[12:15], s30 offen offset:768 lds
    s_add_u32 m0, s31, 6272
    s_nop 0
    buffer_load_dwordx4 v5, s[12:15], s30 offen offset:896 lds
    s_add_u32 m0, s31, 7168
    s_nop 0
    buffer_load_dwordx4 v5, s[12:15], s30 offen offset:1024 lds
    s_add_u32 s27, s27, 1
    s_add_u32 s28, s28, 36864
    s_mov_b32 s32, s42
    s_mov_b32 s33, 0
    s_cmp_eq_u32 s40, 1
    s_cbranch_scc1 QS_35
    s_lshl_b32 s21, s20, 10
    v_add_u32 v8, s21, v7
    s_waitcnt vmcnt(18)
    s_barrier
    v_mov_b32 v9, v11
    v_mov_b32 v10, v12
    ds_read_b128 v[16:19], v9 offset:0
    ds_read_b128 v[20:23], v9 offset:18432
    ds_read_b128 v[24:27], v10 offset:0
    ds_read_b128 v[28:31], v10 offset:18432
    ds_read_b128 v[32:35], v9 offset:1024
    ds_read_b128 v[36:39], v9 offset:19456
QL_34:
    s_add_u32 s34, s33, 36864
    s_cmp_eq_u32 s34, 147456
    s_cselect_b32 s34, 0, s34
    v_add_u32 v13, s34, v11
    v_add_u32 v14, s34, v12
    s_sub_u32 s35, s32, 1
    s_waitcnt lgkmcnt(4)
    ds_read_b128 v[40:43], v10 offset:1024
    ds_read_b128 v[44:47], v10 offset:19456
    v_mfma_f32_16x16x32_bf16 v[48:51], v[64:67], v[16:19], 0
    v_mfma_f32_16x16x32_bf16 v[56:59], v[136:139], v[16:19], 0
    v_mfma_f32_16x16x32_bf16 v[52:55], v[64:67], v[20:23], 0
    v_mfma_f32_16x16x32_bf16 v[60:63], v[136:139], v[20:23], 0
    s_waitcnt lgkmcnt(4)
    ds_read_b128 v[16:19], v9 offset:2048
    ds_read_b128 v[20:23], v9 offset:20480
    v_mfma_f32_16x16x32_bf16 v[48:51], v[68:71], v[24:27], v[48:51]
    v_mfma_f32_16x16x32_bf16 v[56:59], v[140:143], v[24:27], v[56:59]
    v_mfma_f32_16x16x32_bf16 v[52:55], v[68:71], v[28:31], v[52:55]
    v_mfma_f32_16x16x32_bf16 v[60:63], v[140:143], v[28:31], v[60:63]
    s_waitcnt lgkmcnt(4)
    ds_read_b128 v[24:27], v10 offset:2048
    ds_read_b128 v[28:31], v10 offset:20480
    v_mfma_f32_16x16x32_bf16 v[48:51], v[72:75], v[32:35], v[48:51]
    v_mfma_f32_16x16x32_bf16 v[56:59], v[144:147], v[32:35], v[56:59]
    v_mfma_f32_16x16x32_bf16 v[52:55], v[72:75], v[36:39], v[52:55]
    v_mfma_f32_16x16x32_bf16 v[60:63], v[144:147], v[36:39], v[60:63]
    s_cmp_lt_i32 s35, s42
    s_cbranch_scc1 QN_37
    s_lshl_b32 s30, s35, 5
    s_add_u32 s30, s30, s41
    s_lshl_b32 s30, s30, 13
    s_add_u32 s31, s30, 4096
    v_cvt_pk_bf16_f32 v208, v216, v217
    v_cvt_pk_bf16_f32 v209, v218, v219
    v_cvt_pk_bf16_f32 v210, v224, v225
    v_cvt_pk_bf16_f32 v211, v226, v227
    buffer_store_dwordx4 v[208:211], v8, s[16:19], s30 offen sc1
    v_cvt_pk_bf16_f32 v212, v220, v221
    v_cvt_pk_bf16_f32 v213, v222, v223
    v_cvt_pk_bf16_f32 v214, v228, v229
    v_cvt_pk_bf16_f32 v215, v230, v231
    buffer_store_dwordx4 v[212:215], v8, s[16:19], s31 offen sc1
QN_37:
    s_waitcnt lgkmcnt(4)
    ds_read_b128 v[32:35], v9 offset:3072
    ds_read_b128 v[36:39], v9 offset:21504
    v_mfma_f32_16x16x32_bf16 v[48:51], v[76:79], v[40:43], v[48:51]
    v_mfma_f32_16x16x32_bf16 v[56:59], v[148:151], v[40:43], v[56:59]
    v_mfma_f32_16x16x32_bf16 v[52:55], v[76:79], v[44:47], v[52:55]
    v_mfma_f32_16x16x32_bf16 v[60:63], v[148:151], v[44:47], v[60:63]
    s_waitcnt lgkmcnt(4)
    ds_read_b128 v[40:43], v10 offset:3072
    ds_read_b128 v[44:47], v10 offset:21504
    v_mfma_f32_16x16x32_bf16 v[48:51], v[80:83], v[16:19], v[48:51]
    v_mfma_f32_16x16x32_bf16 v[56:59], v[152:155], v[16:19], v[56:59]
    v_mfma_f32_16x16x32_bf16 v[52:55], v[80:83], v[20:23], v[52:55]
    v_mfma_f32_16x16x32_bf16 v[60:63], v[152:155], v[20:23], v[60:63]
    s_waitcnt lgkmcnt(4)
    ds_read_b128 v[16:19], v9 offset:4096
    ds_read_b128 v[20:23], v9 offset:22528
    v_mfma_f32_16x16x32_bf16 v[48:51], v[84:87], v[24:27], v[48:51]
    v_mfma_f32_16x16x32_bf16 v[56:59], v[156:159], v[24:27], v[56:59]
    v_mfma_f32_16x16x32_bf16 v[52:55], v[84:87], v[28:31], v[52:55]
    v_mfma_f32_16x16x32_bf16 v[60:63], v[156:159], v[28:31], v[60:63]
    s_waitcnt lgkmcnt(4)
    ds_read_b128 v[24:27], v10 offset:4096
    ds_read_b128 v[28:31], v10 offset:22528
    v_mfma_f32_16x16x32_bf16 v[48:51], v[88:91], v[32:35], v[48:51]
    v_mfma_f32_16x16x32_bf16 v[56:59], v[160:163], v[32:35], v[56:59]
    v_mfma_f32_16x16x32_bf16 v[52:55], v[88:91], v[36:39], v[52:55]
    v_mfma_f32_16x16x32_bf16 v[60:63], v[160:163], v[36:39], v[60:63]
    s_waitcnt lgkmcnt(4)
    ds_read_b128 v[32:35], v9 offset:5120
    ds_read_b128 v[36:39], v9 offset:23552
    v_mfma_f32_16x16x32_bf16 v[48:51], v[92:95], v[40:43], v[48:51]
    v_mfma_f32_16x16x32_bf16 v[56:59], v[164:167], v[40:43], v[56:59]
    v_mfma_f32_16x16x32_bf16 v[52:55], v[92:95], v[44:47], v[52:55]
    v_mfma_f32_16x16x32_bf16 v[60:63], v[164:167], v[44:47], v[60:63]
    s_waitcnt lgkmcnt(4)
    ds_read_b128 v[40:43], v10 offset:5120
    ds_read_b128 v[44:47], v10 offset:23552
    v_mfma_f32_16x16x32_bf16 v[48:51], v[96:99], v[16:19], v[48:51]
    v_mfma_f32_16x16x32_bf16 v[56:59], v[168:171], v[16:19], v[56:59]
    v_mfma_f32_16x16x32_bf16 v[52:55], v[96:99], v[20:23], v[52:55]
    v_mfma_f32_16x16x32_bf16 v[60:63], v[168:171], v[20:23], v[60:63]
    s_waitcnt lgkmcnt(4)
    ds_read_b128 v[16:19], v9 offset:6144
    ds_read_b128 v[20:23], v9 offset:24576
    s_waitcnt vmcnt(9)
    s_barrier
    s_cmp_lg_u32 s20, 0
    s_cbranch_scc1 QF_38
    s_cmp_lt_u32 s32, 2
    s_cbranch_scc1 QF_38
    s_sub_u32 s38, s32, 1
    v_mov_b32 v15, s38
    s_mov_b64 exec, 1
    buffer_store_dword v15, v1, s[44:47], 0 offen sc1
    s_mov_b64 exec, -1
QF_38:
    s_min_u32 s36, s27, s29
    s_mul_i32 s36, s36, 36864
    s_add_u32 s37, s26, s28
    s_add_u32 m0, s37, 0
    v_mfma_f32_16x16x32_bf16 v[48:51], v[100:103], v[24:27], v[48:51]
    v_mfma_f32_16x16x32_bf16 v[56:59], v[172:175], v[24:27], v[56:59]
    buffer_load_dwordx4 v5, s[12:15], s36 offen offset:0 lds
    v_mfma_f32_16x16x32_bf16 v[52:55], v[100:103], v[28:31], v[52:55]
    v_mfma_f32_16x16x32_bf16 v[60:63], v[172:175], v[28:31], v[60:63]
    s_waitcnt lgkmcnt(4)
    ds_read_b128 v[24:27], v10 offset:6144
    ds_read_b128 v[28:31], v10 offset:24576
    s_add_u32 m0, s37, 896
    v_mfma_f32_16x16x32_bf16 v[48:51], v[104:107], v[32:35], v[48:51]
    v_mfma_f32_16x16x32_bf16 v[56:59], v[176:179], v[32:35], v[56:59]
    buffer_load_dwordx4 v5, s[12:15], s36 offen offset:128 lds
    v_mfma_f32_16x16x32_bf16 v[52:55], v[104:107], v[36:39], v[52:55]
    v_mfma_f32_16x16x32_bf16 v[60:63], v[176:179], v[36:39], v[60:63]
    s_waitcnt lgkmcnt(4)
    ds_read_b128 v[32:35], v9 offset:7168
    ds_read_b128 v[36:39], v9 offset:25600
    s_add_u32 m0, s37, 1792
    v_mfma_f32_16x16x32_bf16 v[48:51], v[108:111], v[40:43], v[48:51]
    v_mfma_f32_16x16x32_bf16 v[56:59], v[180:183], v[40:43], v[56:59]
    buffer_load_dwordx4 v5, s[12:15], s36 offen offset:256 lds
    v_mfma_f32_16x16x32_bf16 v[52:55], v[108:111], v[44:47], v[52:55]
    v_mfma_f32_16x16x32_bf16 v[60:63], v[180:183], v[44:47], v[60:63]
    s_waitcnt lgkmcnt(4)
    ds_read_b128 v[40:43], v10 offset:7168
    ds_read_b128 v[44:47], v10 offset:25600
    s_add_u32 m0, s37, 2688
    v_mfma_f32_16x16x32_bf16 v[48:51], v[112:115], v[16:19], v[48:51]
    v_mfma_f32_16x16x32_bf16 v[56:59], v[184:187], v[16:19], v[56:59]
    buffer_load_dwordx4 v5, s[12:15], s36 offen offset:384 lds
    v_mfma_f32_16x16x32_bf16 v[52:55], v[112:115], v[20:23], v[52:55]
    v_mfma_f32_16x16x32_bf16 v[60:63], v[184:187], v[20:23], v[60:63]
    s_waitcnt lgkmcnt(4)
    ds_read_b128 v[16:19], v9 offset:8192
    ds_read_b128 v[20:23], v9 offset:26624
    s_add_u32 m0, s37, 3584
    v_mfma_f32_16x16x32_bf16 v[48:51], v[116:119], v[24:27], v[48:51]
    v_mfma_f32_16x16x32_bf16 v[56:59], v[188:191], v[24:27], v[56:59]
    buffer_load_dwordx4 v5, s[12:15], s36 offen offset:512 lds
    v_mfma_f32_16x16x32_bf16 v[52:55], v[116:119], v[28:31], v[52:55]
    v_mfma_f32_16x16x32_bf16 v[60:63], v[188:191], v[28:31], v[60:63]
    s_waitcnt lgkmcnt(4)
    ds_read_b128 v[24:27], v10 offset:8192
    ds_read_b128 v[28:31], v10 offset:26624
    s_add_u32 m0, s37, 4480
    v_mfma_f32_16x16x32_bf16 v[48:51], v[120:123], v[32:35], v[48:51]
    v_mfma_f32_16x16x32_bf16 v[56:59], v[192:195], v[32:35], v[56:59]
    buffer_load_dwordx4 v5, s[12:15], s36 offen offset:640 lds
    v_mfma_f32_16x16x32_bf16 v[52:55], v[120:123], v[36:39], v[52:55]
    v_mfma_f32_16x16x32_bf16 v[60:63], v[192:195], v[36:39], v[60:63]
    s_waitcnt lgkmcnt(4)
    ds_read_b128 v[32:35], v13 offset:0
    ds_read_b128 v[36:39], v13 offset:18432
    s_add_u32 m0, s37, 5376
    v_mfma_f32_16x16x32_bf16 v[48:51], v[124:127], v[40:43], v[48:51]
    v_mfma_f32_16x16x32_bf16 v[56:59], v[196:199], v[40:43], v[56:59]
    buffer_load_dwordx4 v5, s[12:15], s36 offen offset:768 lds
    v_mfma_f32_16x16x32_bf16 v[52:55], v[124:127], v[44:47], v[52:55]
    v_mfma_f32_16x16x32_bf16 v[60:63], v[196:199], v[44:47], v[60:63]
    s_waitcnt lgkmcnt(4)
    ds_read_b128 v[40:43], v14 offset:0
    ds_read_b128 v[44:47], v14 offset:18432
    s_add_u32 m0, s37, 6272
    v_mfma_f32_16x16x32_bf16 v[48:51], v[128:131], v[16:19], v[48:51]
    v_mfma_f32_16x16x32_bf16 v[56:59], v[200:203], v[16:19], v[56:59]
    buffer_load_dwordx4 v5, s[12:15], s36 offen offset:896 lds
    v_mfma_f32_16x16x32_bf16 v[52:55], v[128:131], v[20:23], v[52:55]
    v_mfma_f32_16x16x32_bf16 v[60:63], v[200:203], v[20:23], v[60:63]
    s_waitcnt lgkmcnt(4)
    ds_read_b128 v[16:19], v13 offset:1024
    ds_read_b128 v[20:23], v13 offset:19456
    s_add_u32 m0, s37, 7168
    v_mfma_f32_16x16x32_bf16 v[48:51], v[132:135], v[24:27], v[48:51]
    v_mfma_f32_16x16x32_bf16 v[56:59], v[204:207], v[24:27], v[56:59]
    buffer_load_dwordx4 v5, s[12:15], s36 offen offset:1024 lds
    v_mfma_f32_16x16x32_bf16 v[52:55], v[132:135], v[28:31], v[52:55]
    v_mfma_f32_16x16x32_bf16 v[60:63], v[204:207], v[28:31], v[60:63]
    s_add_u32 s27, s27, 1
    s_add_u32 s28, s28, 36864
    s_cmp_eq_u32 s28, 147456
    s_cselect_b32 s28, 0, s28
    s_mov_b32 s33, s34
    v_mov_b32 v9, v13
    v_mov_b32 v10, v14
    s_add_u32 s32, s32, 1
    s_add_u32 s34, s33, 36864
    s_cmp_eq_u32 s34, 147456
    s_cselect_b32 s34, 0, s34
    v_add_u32 v13, s34, v11
    v_add_u32 v14, s34, v12
    s_sub_u32 s35, s32, 1
    s_waitcnt lgkmcnt(4)
    ds_read_b128 v[24:27], v10 offset:1024
    ds_read_b128 v[28:31], v10 offset:19456
    v_mfma_f32_16x16x32_bf16 v[216:219], v[64:67], v[32:35], 0
    v_mfma_f32_16x16x32_bf16 v[224:227], v[136:139], v[32:35], 0
    v_mfma_f32_16x16x32_bf16 v[220:223], v[64:67], v[36:39], 0
    v_mfma_f32_16x16x32_bf16 v[228:231], v[136:139], v[36:39], 0
    s_waitcnt lgkmcnt(4)
    ds_read_b128 v[32:35], v9 offset:2048
    ds_read_b128 v[36:39], v9 offset:20480
    v_mfma_f32_16x16x32_bf16 v[216:219], v[68:71], v[40:43], v[216:219]
    v_mfma_f32_16x16x32_bf16 v[224:227], v[140:143], v[40:43], v[224:227]
    v_mfma_f32_16x16x32_bf16 v[220:223], v[68:71], v[44:47], v[220:223]
    v_mfma_f32_16x16x32_bf16 v[228:231], v[140:143], v[44:47], v[228:231]
    s_waitcnt lgkmcnt(4)
    ds_read_b128 v[40:43], v10 offset:2048
    ds_read_b128 v[44:47], v10 offset:20480
    v_mfma_f32_16x16x32_bf16 v[216:219], v[72:75], v[16:19], v[216:219]
    v_mfma_f32_16x16x32_bf16 v[224:227], v[144:147], v[16:19], v[224:227]
    v_mfma_f32_16x16x32_bf16 v[220:223], v[72:75], v[20:23], v[220:223]
    v_mfma_f32_16x16x32_bf16 v[228:231], v[144:147], v[20:23], v[228:231]
    s_cmp_lt_i32 s35, s42
    s_cbranch_scc1 QN_39
    s_lshl_b32 s30, s35, 5
    s_add_u32 s30, s30, s41
    s_lshl_b32 s30, s30, 13
    s_add_u32 s31, s30, 4096
    v_cvt_pk_bf16_f32 v208, v48, v49
    v_cvt_pk_bf16_f32 v209, v50, v51
    v_cvt_pk_bf16_f32 v210, v56, v57
    v_cvt_pk_bf16_f32 v211, v58, v59
    buffer_store_dwordx4 v[208:211], v8, s[16:19], s30 offen sc1
    v_cvt_pk_bf16_f32 v212, v52, v53
    v_cvt_pk_bf16_f32 v213, v54, v55
    v_cvt_pk_bf16_f32 v214, v60, v61
    v_cvt_pk_bf16_f32 v215, v62, v63
    buffer_store_dwordx4 v[212:215], v8, s[16:19], s31 offen sc1
QN_39:
    s_waitcnt lgkmcnt(4)
    ds_read_b128 v[16:19], v9 offset:3072
    ds_read_b128 v[20:23], v9 offset:21504
    v_mfma_f32_16x16x32_bf16 v[216:219], v[76:79], v[24:27], v[216:219]
    v_mfma_f32_16x16x32_bf16 v[224:227], v[148:151], v[24:27], v[224:227]
    v_mfma_f32_16x16x32_bf16 v[220:223], v[76:79], v[28:31], v[220:223]
    v_mfma_f32_16x16x32_bf16 v[228:231], v[148:151], v[28:31], v[228:231]
    s_waitcnt lgkmcnt(4)
    ds_read_b128 v[24:27], v10 offset:3072
    ds_read_b128 v[28:31], v10 offset:21504
    v_mfma_f32_16x16x32_bf16 v[216:219], v[80:83], v[32:35], v[216:219]
    v_mfma_f32_16x16x32_bf16 v[224:227], v[152:155], v[32:35], v[224:227]
    v_mfma_f32_16x16x32_bf16 v[220:223], v[80:83], v[36:39], v[220:223]
    v_mfma_f32_16x16x32_bf16 v[228:231], v[152:155], v[36:39], v[228:231]
    s_waitcnt lgkmcnt(4)
    ds_read_b128 v[32:35], v9 offset:4096
    ds_read_b128 v[36:39], v9 offset:22528
    v_mfma_f32_16x16x32_bf16 v[216:219], v[84:87], v[40:43], v[216:219]
    v_mfma_f32_16x16x32_bf16 v[224:227], v[156:159], v[40:43], v[224:227]
    v_mfma_f32_16x16x32_bf16 v[220:223], v[84:87], v[44:47], v[220:223]
    v_mfma_f32_16x16x32_bf16 v[228:231], v[156:159], v[44:47], v[228:231]
    s_waitcnt lgkmcnt(4)
    ds_read_b128 v[40:43], v10 offset:4096
    ds_read_b128 v[44:47], v10 offset:22528
    v_mfma_f32_16x16x32_bf16 v[216:219], v[88:91], v[16:19], v[216:219]
    v_mfma_f32_16x16x32_bf16 v[224:227], v[160:163], v[16:19], v[224:227]
    v_mfma_f32_16x16x32_bf16 v[220:223], v[88:91], v[20:23], v[220:223]
    v_mfma_f32_16x16x32_bf16 v[228:231], v[160:163], v[20:23], v[228:231]
    s_waitcnt lgkmcnt(4)
    ds_read_b128 v[16:19], v9 offset:5120
    ds_read_b128 v[20:23], v9 offset:23552
    v_mfma_f32_16x16x32_bf16 v[216:219], v[92:95], v[24:27], v[216:219]
    v_mfma_f32_16x16x32_bf16 v[224:227], v[164:167], v[24:27], v[224:227]
    v_mfma_f32_16x16x32_bf16 v[220:223], v[92:95], v[28:31], v[220:223]
    v_mfma_f32_16x16x32_bf16 v[228:231], v[164:167], v[28:31], v[228:231]
    s_waitcnt lgkmcnt(4)
    ds_read_b128 v[24:27], v10 offset:5120
    ds_read_b128 v[28:31], v10 offset:23552
    v_mfma_f32_16x16x32_bf16 v[216:219], v[96:99], v[32:35], v[216:219]
    v_mfma_f32_16x16x32_bf16 v[224:227], v[168:171], v[32:35], v[224:227]
    v_mfma_f32_16x16x32_bf16 v[220:223], v[96:99], v[36:39], v[220:223]
    v_mfma_f32_16x16x32_bf16 v[228:231], v[168:171], v[36:39], v[228:231]
    s_waitcnt lgkmcnt(4)
    ds_read_b128 v[32:35], v9 offset:6144
    ds_read_b128 v[36:39], v9 offset:24576
    s_waitcnt vmcnt(9)
    s_barrier
    s_cmp_lg_u32 s20, 0
    s_cbranch_scc1 QF_40
    s_cmp_lt_u32 s32, 2
    s_cbranch_scc1 QF_40
    s_sub_u32 s38, s32, 1
    v_mov_b32 v15, s38
    s_mov_b64 exec, 1
    buffer_store_dword v15, v1, s[44:47], 0 offen sc1
    s_mov_b64 exec, -1
QF_40:
    s_min_u32 s36, s27, s29
    s_mul_i32 s36, s36, 36864
    s_add_u32 s37, s26, s28
    s_add_u32 m0, s37, 0
    v_mfma_f32_16x16x32_bf16 v[216:219], v[100:103], v[40:43], v[216:219]
    v_mfma_f32_16x16x32_bf16 v[224:227], v[172:175], v[40:43], v[224:227]
    buffer_load_dwordx4 v5, s[12:15], s36 offen offset:0 lds
    v_mfma_f32_16x16x32_bf16 v[220:223], v[100:103], v[44:47], v[220:223]
    v_mfma_f32_16x16x32_bf16 v[228:231], v[172:175], v[44:47], v[228:231]
    s_waitcnt lgkmcnt(4)
    ds_read_b128 v[40:43], v10 offset:6144
    ds_read_b128 v[44:47], v10 offset:24576
    s_add_u32 m0, s37, 896
    v_mfma_f32_16x16x32_bf16 v[216:219], v[104:107], v[16:19], v[216:219]
    v_mfma_f32_16x16x32_bf16 v[224:227], v[176:179], v[16:19], v[224:227]
    buffer_load_dwordx4 v5, s[12:15], s36 offen offset:128 lds
    v_mfma_f32_16x16x32_bf16 v[220:223], v[104:107], v[20:23], v[220:223]
    v_mfma_f32_16x16x32_bf16 v[228:231], v[176:179], v[20:23], v[228:231]
    s_waitcnt lgkmcnt(4)
    ds_read_b128 v[16:19], v9 offset:7168
    ds_read_b128 v[20:23], v9 offset:25600
    s_add_u32 m0, s37, 1792
    v_mfma_f32_16x16x32_bf16 v[216:219], v[108:111], v[24:27], v[216:219]
    v_mfma_f32_16x16x32_bf16 v[224:227], v[180:183], v[24:27], v[224:227]
    buffer_load_dwordx4 v5, s[12:15], s36 offen offset:256 lds
    v_mfma_f32_16x16x32_bf16 v[220:223], v[108:111], v[28:31], v[220:223]
    v_mfma_f32_16x16x32_bf16 v[228:231], v[180:183], v[28:31], v[228:231]
    s_waitcnt lgkmcnt(4)
    ds_read_b128 v[24:27], v10 offset:7168
    ds_read_b128 v[28:31], v10 offset:25600
    s_add_u32 m0, s37, 2688
    v_mfma_f32_16x16x32_bf16 v[216:219], v[112:115], v[32:35], v[216:219]
    v_mfma_f32_16x16x32_bf16 v[224:227], v[184:187], v[32:35], v[224:227]
    buffer_load_dwordx4 v5, s[12:15], s36 offen offset:384 lds
    v_mfma_f32_16x16x32_bf16 v[220:223], v[112:115], v[36:39], v[220:223]
    v_mfma_f32_16x16x32_bf16 v[228:231], v[184:187], v[36:39], v[228:231]
    s_waitcnt lgkmcnt(4)
    ds_read_b128 v[32:35], v9 offset:8192
    ds_read_b128 v[36:39], v9 offset:26624
    s_add_u32 m0, s37, 3584
    v_mfma_f32_16x16x32_bf16 v[216:219], v[116:119], v[40:43], v[216:219]
    v_mfma_f32_16x16x32_bf16 v[224:227], v[188:191], v[40:43], v[224:227]
    buffer_load_dwordx4 v5, s[12:15], s36 offen offset:512 lds
    v_mfma_f32_16x16x32_bf16 v[220:223], v[116:119], v[44:47], v[220:223]
    v_mfma_f32_16x16x32_bf16 v[228:231], v[188:191], v[44:47], v[228:231]
    s_waitcnt lgkmcnt(4)
    ds_read_b128 v[40:43], v10 offset:8192
    ds_read_b128 v[44:47], v10 offset:26624
    s_add_u32 m0, s37, 4480
    v_mfma_f32_16x16x32_bf16 v[216:219], v[120:123], v[16:19], v[216:219]
    v_mfma_f32_16x16x32_bf16 v[224:227], v[192:195], v[16:19], v[224:227]
    buffer_load_dwordx4 v5, s[12:15], s36 offen offset:640 lds
    v_mfma_f32_16x16x32_bf16 v[220:223], v[120:123], v[20:23], v[220:223]
    v_mfma_f32_16x16x32_bf16 v[228:231], v[192:195], v[20:23], v[228:231]
    s_waitcnt lgkmcnt(4)
    ds_read_b128 v[16:19], v13 offset:0
    ds_read_b128 v[20:23], v13 offset:18432
    s_add_u32 m0, s37, 5376
    v_mfma_f32_16x16x32_bf16 v[216:219], v[124:127], v[24:27], v[216:219]
    v_mfma_f32_16x16x32_bf16 v[224:227], v[196:199], v[24:27], v[224:227]
    buffer_load_dwordx4 v5, s[12:15], s36 offen offset:768 lds
    v_mfma_f32_16x16x32_bf16 v[220:223], v[124:127], v[28:31], v[220:223]
    v_mfma_f32_16x16x32_bf16 v[228:231], v[196:199], v[28:31], v[228:231]
    s_waitcnt lgkmcnt(4)
    ds_read_b128 v[24:27], v14 offset:0
    ds_read_b128 v[28:31], v14 offset:18432
    s_add_u32 m0, s37, 6272
    v_mfma_f32_16x16x32_bf16 v[216:219], v[128:131], v[32:35], v[216:219]
    v_mfma_f32_16x16x32_bf16 v[224:227], v[200:203], v[32:35], v[224:227]
    buffer_load_dwordx4 v5, s[12:15], s36 offen offset:896 lds
    v_mfma_f32_16x16x32_bf16 v[220:223], v[128:131], v[36:39], v[220:223]
    v_mfma_f32_16x16x32_bf16 v[228:231], v[200:203], v[36:39], v[228:231]
    s_waitcnt lgkmcnt(4)
    ds_read_b128 v[32:35], v13 offset:1024
    ds_read_b128 v[36:39], v13 offset:19456
    s_add_u32 m0, s37, 7168
    v_mfma_f32_16x16x32_bf16 v[216:219], v[132:135], v[40:43], v[216:219]
    v_mfma_f32_16x16x32_bf16 v[224:227], v[204:207], v[40:43], v[224:227]
    buffer_load_dwordx4 v5, s[12:15], s36 offen offset:1024 lds
    v_mfma_f32_16x16x32_bf16 v[220:223], v[132:135], v[44:47], v[220:223]
    v_mfma_f32_16x16x32_bf16 v[228:231], v[204:207], v[44:47], v[228:231]
    s_add_u32 s27, s27, 1
    s_add_u32 s28, s28, 36864
    s_cmp_eq_u32 s28, 147456
    s_cselect_b32 s28, 0, s28
    s_mov_b32 s33, s34
    v_mov_b32 v9, v13
    v_mov_b32 v10, v14
    s_add_u32 s32, s32, 1
    s_cmp_le_u32 s32, s29
    s_cbranch_scc1 QL_34
    s_nop 7
    s_nop 7
    s_sub_u32 s35, s32, 1
    s_lshl_b32 s30, s35, 5
    s_add_u32 s30, s30, s41
    s_lshl_b32 s30, s30, 13
    s_add_u32 s31, s30, 4096
    v_cvt_pk_bf16_f32 v208, v216, v217
    v_cvt_pk_bf16_f32 v209, v218, v219
    v_cvt_pk_bf16_f32 v210, v224, v225
    v_cvt_pk_bf16_f32 v211, v226, v227
    buffer_store_dwordx4 v[208:211], v8, s[16:19], s30 offen sc1
    v_cvt_pk_bf16_f32 v212, v220, v221
    v_cvt_pk_bf16_f32 v213, v222, v223
    v_cvt_pk_bf16_f32 v214, v228, v229
    v_cvt_pk_bf16_f32 v215, v230, v231
    buffer_store_dwordx4 v[212:215], v8, s[16:19], s31 offen sc1
    s_waitcnt vmcnt(0) lgkmcnt(0)
    s_barrier
    s_cmp_lg_u32 s20, 0
    s_cbranch_scc1 QF_41
    v_mov_b32 v15, s32
    s_mov_b64 exec, 1
    buffer_store_dword v15, v1, s[44:47], 0 offen sc1
    s_mov_b64 exec, -1
    s_waitcnt vmcnt(0)
QF_41:
    s_branch M_WORK
QS_35:
    s_lshl_b32 s21, s20, 11
    v_add_u32 v8, s21, v7
    s_waitcnt vmcnt(18)
    s_barrier
    v_mov_b32 v9, v11
    v_mov_b32 v10, v12
    ds_read_b128 v[16:19], v9 offset:0
    ds_read_b128 v[20:23], v9 offset:18432
    ds_read_b128 v[24:27], v10 offset:0
    ds_read_b128 v[28:31], v10 offset:18432
    ds_read_b128 v[32:35], v9 offset:1024
    ds_read_b128 v[36:39], v9 offset:19456
QL_42:
    s_add_u32 s34, s33, 36864
    s_cmp_eq_u32 s34, 147456
    s_cselect_b32 s34, 0, s34
    v_add_u32 v13, s34, v11
    v_add_u32 v14, s34, v12
    s_sub_u32 s35, s32, 1
    s_waitcnt lgkmcnt(4)
    ds_read_b128 v[40:43], v10 offset:1024
    ds_read_b128 v[44:47], v10 offset:19456
    v_mfma_f32_16x16x32_bf16 v[48:51], v[16:19], v[64:67], 0
    v_mfma_f32_16x16x32_bf16 v[56:59], v[16:19], v[136:139], 0
    v_mfma_f32_16x16x32_bf16 v[52:55], v[20:23], v[64:67], 0
    v_mfma_f32_16x16x32_bf16 v[60:63], v[20:23], v[136:139], 0
    s_waitcnt lgkmcnt(4)
    ds_read_b128 v[16:19], v9 offset:2048
    ds_read_b128 v[20:23], v9 offset:20480
    v_mfma_f32_16x16x32_bf16 v[48:51], v[24:27], v[68:71], v[48:51]
    v_mfma_f32_16x16x32_bf16 v[56:59], v[24:27], v[140:143], v[56:59]
    v_mfma_f32_16x16x32_bf16 v[52:55], v[28:31], v[68:71], v[52:55]
    v_mfma_f32_16x16x32_bf16 v[60:63], v[28:31], v[140:143], v[60:63]
    s_waitcnt lgkmcnt(4)
    ds_read_b128 v[24:27], v10 offset:2048
    ds_read_b128 v[28:31], v10 offset:20480
    v_mfma_f32_16x16x32_bf16 v[48:51], v[32:35], v[72:75], v[48:51]
    v_mfma_f32_16x16x32_bf16 v[56:59], v[32:35], v[144:147], v[56:59]
    v_mfma_f32_16x16x32_bf16 v[52:55], v[36:39], v[72:75], v[52:55]
    v_mfma_f32_16x16x32_bf16 v[60:63], v[36:39], v[144:147], v[60:63]
    s_cmp_lt_i32 s35, s42
    s_cbranch_scc1 QN_45
    s_lshl_b32 s30, s35, 5
    s_add_u32 s30, s30, s41
    s_lshl_b32 s30, s30, 13
    s_add_u32 s31, s30, 1024
    v_cvt_pk_bf16_f32 v208, v216, v217
    v_cvt_pk_bf16_f32 v209, v218, v219
    v_cvt_pk_bf16_f32 v210, v220, v221
    v_cvt_pk_bf16_f32 v211, v222, v223
    buffer_store_dwordx4 v[208:211], v8, s[16:19], s30 offen sc1
    v_cvt_pk_bf16_f32 v212, v224, v225
    v_cvt_pk_bf16_f32 v213, v226, v227
    v_cvt_pk_bf16_f32 v214, v228, v229
    v_cvt_pk_bf16_f32 v215, v230, v231
    buffer_store_dwordx4 v[212:215], v8, s[16:19], s31 offen sc1
QN_45:
    s_waitcnt lgkmcnt(4)
    ds_read_b128 v[32:35], v9 offset:3072
    ds_read_b128 v[36:39], v9 offset:21504
    v_mfma_f32_16x16x32_bf16 v[48:51], v[40:43], v[76:79], v[48:51]
    v_mfma_f32_16x16x32_bf16 v[56:59], v[40:43], v[148:151], v[56:59]
    v_mfma_f32_16x16x32_bf16 v[52:55], v[44:47], v[76:79], v[52:55]
    v_mfma_f32_16x16x32_bf16 v[60:63], v[44:47], v[148:151], v[60:63]
    s_waitcnt lgkmcnt(4)
    ds_read_b128 v[40:43], v10 offset:3072
    ds_read_b128 v[44:47], v10 offset:21504
    v_mfma_f32_16x16x32_bf16 v[48:51], v[16:19], v[80:83], v[48:51]
    v_mfma_f32_16x16x32_bf16 v[56:59], v[16:19], v[152:155], v[56:59]
    v_mfma_f32_16x16x32_bf16 v[52:55], v[20:23], v[80:83], v[52:55]
    v_mfma_f32_16x16x32_bf16 v[60:63], v[20:23], v[152:155], v[60:63]
    s_waitcnt lgkmcnt(4)
    ds_read_b128 v[16:19], v9 offset:4096
    ds_read_b128 v[20:23], v9 offset:22528
    v_mfma_f32_16x16x32_bf16 v[48:51], v[24:27], v[84:87], v[48:51]
    v_mfma_f32_16x16x32_bf16 v[56:59], v[24:27], v[156:159], v[56:59]
    v_mfma_f32_16x16x32_bf16 v[52:55], v[28:31], v[84:87], v[52:55]
    v_mfma_f32_16x16x32_bf16 v[60:63], v[28:31], v[156:159], v[60:63]
    s_waitcnt lgkmcnt(4)
    ds_read_b128 v[24:27], v10 offset:4096
    ds_read_b128 v[28:31], v10 offset:22528
    v_mfma_f32_16x16x32_bf16 v[48:51], v[32:35], v[88:91], v[48:51]
    v_mfma_f32_16x16x32_bf16 v[56:59], v[32:35], v[160:163], v[56:59]
    v_mfma_f32_16x16x32_bf16 v[52:55], v[36:39], v[88:91], v[52:55]
    v_mfma_f32_16x16x32_bf16 v[60:63], v[36:39], v[160:163], v[60:63]
    s_waitcnt lgkmcnt(4)
    ds_read_b128 v[32:35], v9 offset:5120
    ds_read_b128 v[36:39], v9 offset:23552
    v_mfma_f32_16x16x32_bf16 v[48:51], v[40:43], v[92:95], v[48:51]
    v_mfma_f32_16x16x32_bf16 v[56:59], v[40:43], v[164:167], v[56:59]
    v_mfma_f32_16x16x32_bf16 v[52:55], v[44:47], v[92:95], v[52:55]
    v_mfma_f32_16x16x32_bf16 v[60:63], v[44:47], v[164:167], v[60:63]
    s_waitcnt lgkmcnt(4)
    ds_read_b128 v[40:43], v10 offset:5120
    ds_read_b128 v[44:47], v10 offset:23552
    v_mfma_f32_16x16x32_bf16 v[48:51], v[16:19], v[96:99], v[48:51]
    v_mfma_f32_16x16x32_bf16 v[56:59], v[16:19], v[168:171], v[56:59]
    v_mfma_f32_16x16x32_bf16 v[52:55], v[20:23], v[96:99], v[52:55]
    v_mfma_f32_16x16x32_bf16 v[60:63], v[20:23], v[168:171], v[60:63]
    s_waitcnt lgkmcnt(4)
    ds_read_b128 v[16:19], v9 offset:6144
    ds_read_b128 v[20:23], v9 offset:24576
    s_waitcnt vmcnt(9)
    s_barrier
    s_cmp_lg_u32 s20, 0
    s_cbranch_scc1 QF_46
    s_cmp_lt_u32 s32, 2
    s_cbranch_scc1 QF_46
    s_sub_u32 s38, s32, 1
    v_mov_b32 v15, s38
    s_mov_b64 exec, 1
    buffer_store_dword v15, v1, s[44:47], 0 offen sc1
    s_mov_b64 exec, -1
QF_46:
    s_min_u32 s36, s27, s29
    s_mul_i32 s36, s36, 36864
    s_add_u32 s37, s26, s28
    s_add_u32 m0, s37, 0
    v_mfma_f32_16x16x32_bf16 v[48:51], v[24:27], v[100:103], v[48:51]
    v_mfma_f32_16x16x32_bf16 v[56:59], v[24:27], v[172:175], v[56:59]
    buffer_load_dwordx4 v5, s[12:15], s36 offen offset:0 lds
    v_mfma_f32_16x16x32_bf16 v[52:55], v[28:31], v[100:103], v[52:55]
    v_mfma_f32_16x16x32_bf16 v[60:63], v[28:31], v[172:175], v[60:63]
    s_waitcnt lgkmcnt(4)
    ds_read_b128 v[24:27], v10 offset:6144
    ds_read_b128 v[28:31], v10 offset:24576
    s_add_u32 m0, s37, 896
    v_mfma_f32_16x16x32_bf16 v[48:51], v[32:35], v[104:107], v[48:51]
    v_mfma_f32_16x16x32_bf16 v[56:59], v[32:35], v[176:179], v[56:59]
    buffer_load_dwordx4 v5, s[12:15], s36 offen offset:128 lds
    v_mfma_f32_16x16x32_bf16 v[52:55], v[36:39], v[104:107], v[52:55]
    v_mfma_f32_16x16x32_bf16 v[60:63], v[36:39], v[176:179], v[60:63]
    s_waitcnt lgkmcnt(4)
    ds_read_b128 v[32:35], v9 offset:7168
    ds_read_b128 v[36:39], v9 offset:25600
    s_add_u32 m0, s37, 1792
    v_mfma_f32_16x16x32_bf16 v[48:51], v[40:43], v[108:111], v[48:51]
    v_mfma_f32_16x16x32_bf16 v[56:59], v[40:43], v[180:183], v[56:59]
    buffer_load_dwordx4 v5, s[12:15], s36 offen offset:256 lds
    v_mfma_f32_16x16x32_bf16 v[52:55], v[44:47], v[108:111], v[52:55]
    v_mfma_f32_16x16x32_bf16 v[60:63], v[44:47], v[180:183], v[60:63]
    s_waitcnt lgkmcnt(4)
    ds_read_b128 v[40:43], v10 offset:7168
    ds_read_b128 v[44:47], v10 offset:25600
    s_add_u32 m0, s37, 2688
    v_mfma_f32_16x16x32_bf16 v[48:51], v[16:19], v[112:115], v[48:51]
    v_mfma_f32_16x16x32_bf16 v[56:59], v[16:19], v[184:187], v[56:59]
    buffer_load_dwordx4 v5, s[12:15], s36 offen offset:384 lds
    v_mfma_f32_16x16x32_bf16 v[52:55], v[20:23], v[112:115], v[52:55]
    v_mfma_f32_16x16x32_bf16 v[60:63], v[20:23], v[184:187], v[60:63]
    s_waitcnt lgkmcnt(4)
    ds_read_b128 v[16:19], v9 offset:8192
    ds_read_b128 v[20:23], v9 offset:26624
    s_add_u32 m0, s37, 3584
    v_mfma_f32_16x16x32_bf16 v[48:51], v[24:27], v[116:119], v[48:51]
    v_mfma_f32_16x16x32_bf16 v[56:59], v[24:27], v[188:191], v[56:59]
    buffer_load_dwordx4 v5, s[12:15], s36 offen offset:512 lds
    v_mfma_f32_16x16x32_bf16 v[52:55], v[28:31], v[116:119], v[52:55]
    v_mfma_f32_16x16x32_bf16 v[60:63], v[28:31], v[188:191], v[60:63]
    s_waitcnt lgkmcnt(4)
    ds_read_b128 v[24:27], v10 offset:8192
    ds_read_b128 v[28:31], v10 offset:26624
    s_add_u32 m0, s37, 4480
    v_mfma_f32_16x16x32_bf16 v[48:51], v[32:35], v[120:123], v[48:51]
    v_mfma_f32_16x16x32_bf16 v[56:59], v[32:35], v[192:195], v[56:59]
    buffer_load_dwordx4 v5, s[12:15], s36 offen offset:640 lds
    v_mfma_f32_16x16x32_bf16 v[52:55], v[36:39], v[120:123], v[52:55]
    v_mfma_f32_16x16x32_bf16 v[60:63], v[36:39], v[192:195], v[60:63]
    s_waitcnt lgkmcnt(4)
    ds_read_b128 v[32:35], v13 offset:0
    ds_read_b128 v[36:39], v13 offset:18432
    s_add_u32 m0, s37, 5376
    v_mfma_f32_16x16x32_bf16 v[48:51], v[40:43], v[124:127], v[48:51]
    v_mfma_f32_16x16x32_bf16 v[56:59], v[40:43], v[196:199], v[56:59]
    buffer_load_dwordx4 v5, s[12:15], s36 offen offset:768 lds
    v_mfma_f32_16x16x32_bf16 v[52:55], v[44:47], v[124:127], v[52:55]
    v_mfma_f32_16x16x32_bf16 v[60:63], v[44:47], v[196:199], v[60:63]
    s_waitcnt lgkmcnt(4)
    ds_read_b128 v[40:43], v14 offset:0
    ds_read_b128 v[44:47], v14 offset:18432
    s_add_u32 m0, s37, 6272
    v_mfma_f32_16x16x32_bf16 v[48:51], v[16:19], v[128:131], v[48:51]
    v_mfma_f32_16x16x32_bf16 v[56:59], v[16:19], v[200:203], v[56:59]
    buffer_load_dwordx4 v5, s[12:15], s36 offen offset:896 lds
    v_mfma_f32_16x16x32_bf16 v[52:55], v[20:23], v[128:131], v[52:55]
    v_mfma_f32_16x16x32_bf16 v[60:63], v[20:23], v[200:203], v[60:63]
    s_waitcnt lgkmcnt(4)
    ds_read_b128 v[16:19], v13 offset:1024
    ds_read_b128 v[20:23], v13 offset:19456
    s_add_u32 m0, s37, 7168
    v_mfma_f32_16x16x32_bf16 v[48:51], v[24:27], v[132:135], v[48:51]
    v_mfma_f32_16x16x32_bf16 v[56:59], v[24:27], v[204:207], v[56:59]
    buffer_load_dwordx4 v5, s[12:15], s36 offen offset:1024 lds
    v_mfma_f32_16x16x32_bf16 v[52:55], v[28:31], v[132:135], v[52:55]
    v_mfma_f32_16x16x32_bf16 v[60:63], v[28:31], v[204:207], v[60:63]
    s_add_u32 s27, s27, 1
    s_add_u32 s28, s28, 36864
    s_cmp_eq_u32 s28, 147456
    s_cselect_b32 s28, 0, s28
    s_mov_b32 s33, s34
    v_mov_b32 v9, v13
    v_mov_b32 v10, v14
    s_add_u32 s32, s32, 1
    s_add_u32 s34, s33, 36864
    s_cmp_eq_u32 s34, 147456
    s_cselect_b32 s34, 0, s34
    v_add_u32 v13, s34, v11
    v_add_u32 v14, s34, v12
    s_sub_u32 s35, s32, 1
    s_waitcnt lgkmcnt(4)
    ds_read_b128 v[24:27], v10 offset:1024
    ds_read_b128 v[28:31], v10 offset:19456
    v_mfma_f32_16x16x32_bf16 v[216:219], v[32:35], v[64:67], 0
    v_mfma_f32_16x16x32_bf16 v[224:227], v[32:35], v[136:139], 0
    v_mfma_f32_16x16x32_bf16 v[220:223], v[36:39], v[64:67], 0
    v_mfma_f32_16x16x32_bf16 v[228:231], v[36:39], v[136:139], 0
    s_waitcnt lgkmcnt(4)
    ds_read_b128 v[32:35], v9 offset:2048
    ds_read_b128 v[36:39], v9 offset:20480
    v_mfma_f32_16x16x32_bf16 v[216:219], v[40:43], v[68:71], v[216:219]
    v_mfma_f32_16x16x32_bf16 v[224:227], v[40:43], v[140:143], v[224:227]
    v_mfma_f32_16x16x32_bf16 v[220:223], v[44:47], v[68:71], v[220:223]
    v_mfma_f32_16x16x32_bf16 v[228:231], v[44:47], v[140:143], v[228:231]
    s_waitcnt lgkmcnt(4)
    ds_read_b128 v[40:43], v10 offset:2048
    ds_read_b128 v[44:47], v10 offset:20480
    v_mfma_f32_16x16x32_bf16 v[216:219], v[16:19], v[72:75], v[216:219]
    v_mfma_f32_16x16x32_bf16 v[224:227], v[16:19], v[144:147], v[224:227]
    v_mfma_f32_16x16x32_bf16 v[220:223], v[20:23], v[72:75], v[220:223]
    v_mfma_f32_16x16x32_bf16 v[228:231], v[20:23], v[144:147], v[228:231]
    s_cmp_lt_i32 s35, s42
    s_cbranch_scc1 QN_47
    s_lshl_b32 s30, s35, 5
    s_add_u32 s30, s30, s41
    s_lshl_b32 s30, s30, 13
    s_add_u32 s31, s30, 1024
    v_cvt_pk_bf16_f32 v208, v48, v49
    v_cvt_pk_bf16_f32 v209, v50, v51
    v_cvt_pk_bf16_f32 v210, v52, v53
    v_cvt_pk_bf16_f32 v211, v54, v55
    buffer_store_dwordx4 v[208:211], v8, s[16:19], s30 offen sc1
    v_cvt_pk_bf16_f32 v212, v56, v57
    v_cvt_pk_bf16_f32 v213, v58, v59
    v_cvt_pk_bf16_f32 v214, v60, v61
    v_cvt_pk_bf16_f32 v215, v62, v63
    buffer_store_dwordx4 v[212:215], v8, s[16:19], s31 offen sc1
QN_47:
    s_waitcnt lgkmcnt(4)
    ds_read_b128 v[16:19], v9 offset:3072
    ds_read_b128 v[20:23], v9 offset:21504
    v_mfma_f32_16x16x32_bf16 v[216:219], v[24:27], v[76:79], v[216:219]
    v_mfma_f32_16x16x32_bf16 v[224:227], v[24:27], v[148:151], v[224:227]
    v_mfma_f32_16x16x32_bf16 v[220:223], v[28:31], v[76:79], v[220:223]
    v_mfma_f32_16x16x32_bf16 v[228:231], v[28:31], v[148:151], v[228:231]
    s_waitcnt lgkmcnt(4)
    ds_read_b128 v[24:27], v10 offset:3072
    ds_read_b128 v[28:31], v10 offset:21504
    v_mfma_f32_16x16x32_bf16 v[216:219], v[32:35], v[80:83], v[216:219]
    v_mfma_f32_16x16x32_bf16 v[224:227], v[32:35], v[152:155], v[224:227]
    v_mfma_f32_16x16x32_bf16 v[220:223], v[36:39], v[80:83], v[220:223]
    v_mfma_f32_16x16x32_bf16 v[228:231], v[36:39], v[152:155], v[228:231]
    s_waitcnt lgkmcnt(4)
    ds_read_b128 v[32:35], v9 offset:4096
    ds_read_b128 v[36:39], v9 offset:22528
    v_mfma_f32_16x16x32_bf16 v[216:219], v[40:43], v[84:87], v[216:219]
    v_mfma_f32_16x16x32_bf16 v[224:227], v[40:43], v[156:159], v[224:227]
    v_mfma_f32_16x16x32_bf16 v[220:223], v[44:47], v[84:87], v[220:223]
    v_mfma_f32_16x16x32_bf16 v[228:231], v[44:47], v[156:159], v[228:231]
    s_waitcnt lgkmcnt(4)
    ds_read_b128 v[40:43], v10 offset:4096
    ds_read_b128 v[44:47], v10 offset:22528
    v_mfma_f32_16x16x32_bf16 v[216:219], v[16:19], v[88:91], v[216:219]
    v_mfma_f32_16x16x32_bf16 v[224:227], v[16:19], v[160:163], v[224:227]
    v_mfma_f32_16x16x32_bf16 v[220:223], v[20:23], v[88:91], v[220:223]
    v_mfma_f32_16x16x32_bf16 v[228:231], v[20:23], v[160:163], v[228:231]
    s_waitcnt lgkmcnt(4)
    ds_read_b128 v[16:19], v9 offset:5120
    ds_read_b128 v[20:23], v9 offset:23552
    v_mfma_f32_16x16x32_bf16 v[216:219], v[24:27], v[92:95], v[216:219]
    v_mfma_f32_16x16x32_bf16 v[224:227], v[24:27], v[164:167], v[224:227]
    v_mfma_f32_16x16x32_bf16 v[220:223], v[28:31], v[92:95], v[220:223]
    v_mfma_f32_16x16x32_bf16 v[228:231], v[28:31], v[164:167], v[228:231]
    s_waitcnt lgkmcnt(4)
    ds_read_b128 v[24:27], v10 offset:5120
    ds_read_b128 v[28:31], v10 offset:23552
    v_mfma_f32_16x16x32_bf16 v[216:219], v[32:35], v[96:99], v[216:219]
    v_mfma_f32_16x16x32_bf16 v[224:227], v[32:35], v[168:171], v[224:227]
    v_mfma_f32_16x16x32_bf16 v[220:223], v[36:39], v[96:99], v[220:223]
    v_mfma_f32_16x16x32_bf16 v[228:231], v[36:39], v[168:171], v[228:231]
    s_waitcnt lgkmcnt(4)
    ds_read_b128 v[32:35], v9 offset:6144
    ds_read_b128 v[36:39], v9 offset:24576
    s_waitcnt vmcnt(9)
    s_barrier
    s_cmp_lg_u32 s20, 0
    s_cbranch_scc1 QF_48
    s_cmp_lt_u32 s32, 2
    s_cbranch_scc1 QF_48
    s_sub_u32 s38, s32, 1
    v_mov_b32 v15, s38
    s_mov_b64 exec, 1
    buffer_store_dword v15, v1, s[44:47], 0 offen sc1
    s_mov_b64 exec, -1
QF_48:
    s_min_u32 s36, s27, s29
    s_mul_i32 s36, s36, 36864
    s_add_u32 s37, s26, s28
    s_add_u32 m0, s37, 0
    v_mfma_f32_16x16x32_bf16 v[216:219], v[40:43], v[100:103], v[216:219]
    v_mfma_f32_16x16x32_bf16 v[224:227], v[40:43], v[172:175], v[224:227]
    buffer_load_dwordx4 v5, s[12:15], s36 offen offset:0 lds
    v_mfma_f32_16x16x32_bf16 v[220:223], v[44:47], v[100:103], v[220:223]
    v_mfma_f32_16x16x32_bf16 v[228:231], v[44:47], v[172:175], v[228:231]
    s_waitcnt lgkmcnt(4)
    ds_read_b128 v[40:43], v10 offset:6144
    ds_read_b128 v[44:47], v10 offset:24576
    s_add_u32 m0, s37, 896
    v_mfma_f32_16x16x32_bf16 v[216:219], v[16:19], v[104:107], v[216:219]
    v_mfma_f32_16x16x32_bf16 v[224:227], v[16:19], v[176:179], v[224:227]
    buffer_load_dwordx4 v5, s[12:15], s36 offen offset:128 lds
    v_mfma_f32_16x16x32_bf16 v[220:223], v[20:23], v[104:107], v[220:223]
    v_mfma_f32_16x16x32_bf16 v[228:231], v[20:23], v[176:179], v[228:231]
    s_waitcnt lgkmcnt(4)
    ds_read_b128 v[16:19], v9 offset:7168
    ds_read_b128 v[20:23], v9 offset:25600
    s_add_u32 m0, s37, 1792
    v_mfma_f32_16x16x32_bf16 v[216:219], v[24:27], v[108:111], v[216:219]
    v_mfma_f32_16x16x32_bf16 v[224:227], v[24:27], v[180:183], v[224:227]
    buffer_load_dwordx4 v5, s[12:15], s36 offen offset:256 lds
    v_mfma_f32_16x16x32_bf16 v[220:223], v[28:31], v[108:111], v[220:223]
    v_mfma_f32_16x16x32_bf16 v[228:231], v[28:31], v[180:183], v[228:231]
    s_waitcnt lgkmcnt(4)
    ds_read_b128 v[24:27], v10 offset:7168
    ds_read_b128 v[28:31], v10 offset:25600
    s_add_u32 m0, s37, 2688
    v_mfma_f32_16x16x32_bf16 v[216:219], v[32:35], v[112:115], v[216:219]
    v_mfma_f32_16x16x32_bf16 v[224:227], v[32:35], v[184:187], v[224:227]
    buffer_load_dwordx4 v5, s[12:15], s36 offen offset:384 lds
    v_mfma_f32_16x16x32_bf16 v[220:223], v[36:39], v[112:115], v[220:223]
    v_mfma_f32_16x16x32_bf16 v[228:231], v[36:39], v[184:187], v[228:231]
    s_waitcnt lgkmcnt(4)
    ds_read_b128 v[32:35], v9 offset:8192
    ds_read_b128 v[36:39], v9 offset:26624
    s_add_u32 m0, s37, 3584
    v_mfma_f32_16x16x32_bf16 v[216:219], v[40:43], v[116:119], v[216:219]
    v_mfma_f32_16x16x32_bf16 v[224:227], v[40:43], v[188:191], v[224:227]
    buffer_load_dwordx4 v5, s[12:15], s36 offen offset:512 lds
    v_mfma_f32_16x16x32_bf16 v[220:223], v[44:47], v[116:119], v[220:223]
    v_mfma_f32_16x16x32_bf16 v[228:231], v[44:47], v[188:191], v[228:231]
    s_waitcnt lgkmcnt(4)
    ds_read_b128 v[40:43], v10 offset:8192
    ds_read_b128 v[44:47], v10 offset:26624
    s_add_u32 m0, s37, 4480
    v_mfma_f32_16x16x32_bf16 v[216:219], v[16:19], v[120:123], v[216:219]
    v_mfma_f32_16x16x32_bf16 v[224:227], v[16:19], v[192:195], v[224:227]
    buffer_load_dwordx4 v5, s[12:15], s36 offen offset:640 lds
    v_mfma_f32_16x16x32_bf16 v[220:223], v[20:23], v[120:123], v[220:223]
    v_mfma_f32_16x16x32_bf16 v[228:231], v[20:23], v[192:195], v[228:231]
    s_waitcnt lgkmcnt(4)
    ds_read_b128 v[16:19], v13 offset:0
    ds_read_b128 v[20:23], v13 offset:18432
    s_add_u32 m0, s37, 5376
    v_mfma_f32_16x16x32_bf16 v[216:219], v[24:27], v[124:127], v[216:219]
    v_mfma_f32_16x16x32_bf16 v[224:227], v[24:27], v[196:199], v[224:227]
    buffer_load_dwordx4 v5, s[12:15], s36 offen offset:768 lds
    v_mfma_f32_16x16x32_bf16 v[220:223], v[28:31], v[124:127], v[220:223]
    v_mfma_f32_16x16x32_bf16 v[228:231], v[28:31], v[196:199], v[228:231]
    s_waitcnt lgkmcnt(4)
    ds_read_b128 v[24:27], v14 offset:0
    ds_read_b128 v[28:31], v14 offset:18432
    s_add_u32 m0, s37, 6272
    v_mfma_f32_16x16x32_bf16 v[216:219], v[32:35], v[128:131], v[216:219]
    v_mfma_f32_16x16x32_bf16 v[224:227], v[32:35], v[200:203], v[224:227]
    buffer_load_dwordx4 v5, s[12:15], s36 offen offset:896 lds
    v_mfma_f32_16x16x32_bf16 v[220:223], v[36:39], v[128:131], v[220:223]
    v_mfma_f32_16x16x32_bf16 v[228:231], v[36:39], v[200:203], v[228:231]
    s_waitcnt lgkmcnt(4)
    ds_read_b128 v[32:35], v13 offset:1024
    ds_read_b128 v[36:39], v13 offset:19456
    s_add_u32 m0, s37, 7168
    v_mfma_f32_16x16x32_bf16 v[216:219], v[40:43], v[132:135], v[216:219]
    v_mfma_f32_16x16x32_bf16 v[224:227], v[40:43], v[204:207], v[224:227]
    buffer_load_dwordx4 v5, s[12:15], s36 offen offset:1024 lds
    v_mfma_f32_16x16x32_bf16 v[220:223], v[44:47], v[132:135], v[220:223]
    v_mfma_f32_16x16x32_bf16 v[228:231], v[44:47], v[204:207], v[228:231]
    s_add_u32 s27, s27, 1
    s_add_u32 s28, s28, 36864
    s_cmp_eq_u32 s28, 147456
    s_cselect_b32 s28, 0, s28
    s_mov_b32 s33, s34
    v_mov_b32 v9, v13
    v_mov_b32 v10, v14
    s_add_u32 s32, s32, 1
    s_cmp_le_u32 s32, s29
    s_cbranch_scc1 QL_42
    s_nop 7
    s_nop 7
    s_sub_u32 s35, s32, 1
    s_lshl_b32 s30, s35, 5
    s_add_u32 s30, s30, s41
    s_lshl_b32 s30, s30, 13
    s_add_u32 s31, s30, 1024
    v_cvt_pk_bf16_f32 v208, v216, v217
    v_cvt_pk_bf16_f32 v209, v218, v219
    v_cvt_pk_bf16_f32 v210, v220, v221
    v_cvt_pk_bf16_f32 v211, v222, v223
    buffer_store_dwordx4 v[208:211], v8, s[16:19], s30 offen sc1
    v_cvt_pk_bf16_f32 v212, v224, v225
    v_cvt_pk_bf16_f32 v213, v226, v227
    v_cvt_pk_bf16_f32 v214, v228, v229
    v_cvt_pk_bf16_f32 v215, v230, v231
    buffer_store_dwordx4 v[212:215], v8, s[16:19], s31 offen sc1
    s_waitcnt vmcnt(0) lgkmcnt(0)
    s_barrier
    s_cmp_lg_u32 s20, 0
    s_cbranch_scc1 QF_49
    v_mov_b32 v15, s32
    s_mov_b64 exec, 1
    buffer_store_dword v15, v1, s[44:47], 0 offen sc1
    s_mov_b64 exec, -1
    s_waitcnt vmcnt(0)
QF_49:
    s_branch M_WORK
M_D1:
    s_cmp_ge_u32 s39, 160
    s_cbranch_scc1 M_D1B
    s_sub_u32 s40, s39, 96
    s_lshl_b32 s40, s40, 2
    s_add_u32 s40, s40, s20
    s_load_dwordx2 s[4:5], s[0:1], 40
    s_load_dwordx2 s[6:7], s[0:1], 144
    s_waitcnt lgkmcnt(0)
    s_mov_b32 s8, s4
    s_mov_b32 s9, s5
    s_mov_b32 s10, 4718592
    s_mov_b32 s11, 0x00020000
    s_add_u32 s12, s6, 85983232
    s_addc_u32 s13, s7, 0
    s_mov_b32 s14, 4718592
    s_mov_b32 s15, 0x00020000
    v_lshrrev_b32 v1, 4, v0
    v_mul_u32_u24 v1, 4608, v1
    v_and_b32 v2, 15, v0
    v_lshl_add_u32 v1, v2, 1, v1
    v_lshlrev_b32 v2, 4, v0
    s_mov_b32 s24, s40
    s_mov_b32 s25, 3
WP_50:
    s_add_u32 s21, s24, 0
    s_mul_i32 s22, s21, 58255
    s_lshr_b32 s22, s22, 21
    s_mul_i32 s23, s22, 36
    s_sub_u32 s23, s21, s23
    s_mul_i32 s22, s22, 36864
    s_lshl_b32 s23, s23, 5
    s_add_u32 s22, s22, s23
    s_add_u32 s26, s22, 0
    buffer_load_ushort v8, v1, s[8:11], s26 offen
    s_add_u32 s26, s22, 1152
    buffer_load_ushort v9, v1, s[8:11], s26 offen
    s_add_u32 s26, s22, 2304
    buffer_load_ushort v10, v1, s[8:11], s26 offen
    s_add_u32 s26, s22, 3456
    buffer_load_ushort v11, v1, s[8:11], s26 offen
    s_add_u32 s26, s22, 18432
    buffer_load_ushort v12, v1, s[8:11], s26 offen
    s_add_u32 s26, s22, 19584
    buffer_load_ushort v13, v1, s[8:11], s26 offen
    s_add_u32 s26, s22, 20736
    buffer_load_ushort v14, v1, s[8:11], s26 offen
    s_add_u32 s26, s22, 21888
    buffer_load_ushort v15, v1, s[8:11], s26 offen
    s_add_u32 s21, s24, 256
    s_mul_i32 s22, s21, 58255
    s_lshr_b32 s22, s22, 21
    s_mul_i32 s23, s22, 36
    s_sub_u32 s23, s21, s23
    s_mul_i32 s22, s22, 36864
    s_lshl_b32 s23, s23, 5
    s_add_u32 s22, s22, s23
    s_add_u32 s26, s22, 0
    buffer_load_ushort v16, v1, s[8:11], s26 offen
    s_add_u32 s26, s22, 1152
    buffer_load_ushort v17, v1, s[8:11], s26 offen
    s_add_u32 s26, s22, 2304
    buffer_load_ushort v18, v1, s[8:11], s26 offen
    s_add_u32 s26, s22, 3456
    buffer_load_ushort v19, v1, s[8:11], s26 offen
    s_add_u32 s26, s22, 18432
    buffer_load_ushort v20, v1, s[8:11], s26 offen
    s_add_u32 s26, s22, 19584
    buffer_load_ushort v21, v1, s[8:11], s26 offen
    s_add_u32 s26, s22, 20736
    buffer_load_ushort v22, v1, s[8:11], s26 offen
    s_add_u32 s26, s22, 21888
    buffer_load_ushort v23, v1, s[8:11], s26 offen
    s_add_u32 s21, s24, 512
    s_mul_i32 s22, s21, 58255
    s_lshr_b32 s22, s22, 21
    s_mul_i32 s23, s22, 36
    s_sub_u32 s23, s21, s23
    s_mul_i32 s22, s22, 36864
    s_lshl_b32 s23, s23, 5
    s_add_u32 s22, s22, s23
    s_add_u32 s26, s22, 0
    buffer_load_ushort v24, v1, s[8:11], s26 offen
    s_add_u32 s26, s22, 1152
    buffer_load_ushort v25, v1, s[8:11], s26 offen
    s_add_u32 s26, s22, 2304
    buffer_load_ushort v26, v1, s[8:11], s26 offen
    s_add_u32 s26, s22, 3456
    buffer_load_ushort v27, v1, s[8:11], s26 offen
    s_add_u32 s26, s22, 18432
    buffer_load_ushort v28, v1, s[8:11], s26 offen
    s_add_u32 s26, s22, 19584
    buffer_load_ushort v29, v1, s[8:11], s26 offen
    s_add_u32 s26, s22, 20736
    buffer_load_ushort v30, v1, s[8:11], s26 offen
    s_add_u32 s26, s22, 21888
    buffer_load_ushort v31, v1, s[8:11], s26 offen
    s_add_u32 s21, s24, 768
    s_mul_i32 s22, s21, 58255
    s_lshr_b32 s22, s22, 21
    s_mul_i32 s23, s22, 36
    s_sub_u32 s23, s21, s23
    s_mul_i32 s22, s22, 36864
    s_lshl_b32 s23, s23, 5
    s_add_u32 s22, s22, s23
    s_add_u32 s26, s22, 0
    buffer_load_ushort v32, v1, s[8:11], s26 offen
    s_add_u32 s26, s22, 1152
    buffer_load_ushort v33, v1, s[8:11], s26 offen
    s_add_u32 s26, s22, 2304
    buffer_load_ushort v34, v1, s[8:11], s26 offen
    s_add_u32 s26, s22, 3456
    buffer_load_ushort v35, v1, s[8:11], s26 offen
    s_add_u32 s26, s22, 18432
    buffer_load_ushort v36, v1, s[8:11], s26 offen
    s_add_u32 s26, s22, 19584
    buffer_load_ushort v37, v1, s[8:11], s26 offen
    s_add_u32 s26, s22, 20736
    buffer_load_ushort v38, v1, s[8:11], s26 offen
    s_add_u32 s26, s22, 21888
    buffer_load_ushort v39, v1, s[8:11], s26 offen
    s_add_u32 s21, s24, 1024
    s_mul_i32 s22, s21, 58255
    s_lshr_b32 s22, s22, 21
    s_mul_i32 s23, s22, 36
    s_sub_u32 s23, s21, s23
    s_mul_i32 s22, s22, 36864
    s_lshl_b32 s23, s23, 5
    s_add_u32 s22, s22, s23
    s_add_u32 s26, s22, 0
    buffer_load_ushort v40, v1, s[8:11], s26 offen
    s_add_u32 s26, s22, 1152
    buffer_load_ushort v41, v1, s[8:11], s26 offen
    s_add_u32 s26, s22, 2304
    buffer_load_ushort v42, v1, s[8:11], s26 offen
    s_add_u32 s26, s22, 3456
    buffer_load_ushort v43, v1, s[8:11], s26 offen
    s_add_u32 s26, s22, 18432
    buffer_load_ushort v44, v1, s[8:11], s26 offen
    s_add_u32 s26, s22, 19584
    buffer_load_ushort v45, v1, s[8:11], s26 offen
    s_add_u32 s26, s22, 20736
    buffer_load_ushort v46, v1, s[8:11], s26 offen
    s_add_u32 s26, s22, 21888
    buffer_load_ushort v47, v1, s[8:11], s26 offen
    s_add_u32 s21, s24, 1280
    s_mul_i32 s22, s21, 58255
    s_lshr_b32 s22, s22, 21
    s_mul_i32 s23, s22, 36
    s_sub_u32 s23, s21, s23
    s_mul_i32 s22, s22, 36864
    s_lshl_b32 s23, s23, 5
    s_add_u32 s22, s22, s23
    s_add_u32 s26, s22, 0
    buffer_load_ushort v48, v1, s[8:11], s26 offen
    s_add_u32 s26, s22, 1152
    buffer_load_ushort v49, v1, s[8:11], s26 offen
    s_add_u32 s26, s22, 2304
    buffer_load_ushort v50, v1, s[8:11], s26 offen
    s_add_u32 s26, s22, 3456
    buffer_load_ushort v51, v1, s[8:11], s26 offen
    s_add_u32 s26, s22, 18432
    buffer_load_ushort v52, v1, s[8:11], s26 offen
    s_add_u32 s26, s22, 19584
    buffer_load_ushort v53, v1, s[8:11], s26 offen
    s_add_u32 s26, s22, 20736
    buffer_load_ushort v54, v1, s[8:11], s26 offen
    s_add_u32 s26, s22, 21888
    buffer_load_ushort v55, v1, s[8:11], s26 offen
    s_waitcnt vmcnt(0)
    s_add_u32 s21, s24, 0
    s_lshl_b32 s21, s21, 10
    v_lshl_or_b32 v8, v9, 16, v8
    v_lshl_or_b32 v9, v11, 16, v10
    v_lshl_or_b32 v10, v13, 16, v12
    v_lshl_or_b32 v11, v15, 16, v14
    buffer_store_dwordx4 v[8:11], v2, s[12:15], s21 offen sc1
    s_add_u32 s21, s24, 256
    s_lshl_b32 s21, s21, 10
    v_lshl_or_b32 v16, v17, 16, v16
    v_lshl_or_b32 v17, v19, 16, v18
    v_lshl_or_b32 v18, v21, 16, v20
    v_lshl_or_b32 v19, v23, 16, v22
    buffer_store_dwordx4 v[16:19], v2, s[12:15], s21 offen sc1
    s_add_u32 s21, s24, 512
    s_lshl_b32 s21, s21, 10
    v_lshl_or_b32 v24, v25, 16, v24
    v_lshl_or_b32 v25, v27, 16, v26
    v_lshl_or_b32 v26, v29, 16, v28
    v_lshl_or_b32 v27, v31, 16, v30
    buffer_store_dwordx4 v[24:27], v2, s[12:15], s21 offen sc1
    s_add_u32 s21, s24, 768
    s_lshl_b32 s21, s21, 10
    v_lshl_or_b32 v32, v33, 16, v32
    v_lshl_or_b32 v33, v35, 16, v34
    v_lshl_or_b32 v34, v37, 16, v36
    v_lshl_or_b32 v35, v39, 16, v38
    buffer_store_dwordx4 v[32:35], v2, s[12:15], s21 offen sc1
    s_add_u32 s21, s24, 1024
    s_lshl_b32 s21, s21, 10
    v_lshl_or_b32 v40, v41, 16, v40
    v_lshl_or_b32 v41, v43, 16, v42
    v_lshl_or_b32 v42, v45, 16, v44
    v_lshl_or_b32 v43, v47, 16, v46
    buffer_store_dwordx4 v[40:43], v2, s[12:15], s21 offen sc1
    s_add_u32 s21, s24, 1280
    s_lshl_b32 s21, s21, 10
    v_lshl_or_b32 v48, v49, 16, v48
    v_lshl_or_b32 v49, v51, 16, v50
    v_lshl_or_b32 v50, v53, 16, v52
    v_lshl_or_b32 v51, v55, 16, v54
    buffer_store_dwordx4 v[48:51], v2, s[12:15], s21 offen sc1
    s_add_u32 s24, s24, 1536
    s_sub_u32 s25, s25, 1
    s_cmp_lg_u32 s25, 0
    s_cbranch_scc1 WP_50
    s_waitcnt vmcnt(0)
    s_barrier
    s_cmp_lg_u32 s20, 0
    s_cbranch_scc1 M_WORK
    s_load_dwordx2 s[4:5], s[0:1], 136
    s_waitcnt lgkmcnt(0)
    s_mov_b32 s8, s4
    s_mov_b32 s9, s5
    s_mov_b32 s10, 256
    s_mov_b32 s11, 0x00020000
    v_mov_b32 v2, 40
    v_mov_b32 v3, 1
    s_mov_b64 exec, 1
    buffer_atomic_add v3, v2, s[8:11], 0 offen sc1
    s_mov_b64 exec, -1
    s_waitcnt vmcnt(0)
    s_branch M_WORK
M_D1B:
    s_cmp_ge_u32 s39, 304
    s_cbranch_scc1 M_D2
    s_mul_i32 s44, s20, 22016
    v_lshlrev_b32 v6, 5, v0
    v_sub_u32 v6, 2051, v6
    s_add_u32 s21, s44, 18688
    v_subrev_u32 v7, 0, v6
    v_min_u32 v7, 2047, v7
    v_cvt_f32_u32 v8, v7
    v_cvt_pk_bf16_f32 v8, v8, v8
    v_and_b32 v8, 0xffff, v8
    v_subrev_u32 v8, 17024, v8
    v_cmp_gt_u32 vcc, 128, v7
    v_cndmask_b32 v7, v8, v7, vcc
    v_lshrrev_b32 v8, 4, v7
    v_add_u32 v7, v7, v8
    v_lshl_add_u32 v200, v7, 2, s21
    v_subrev_u32 v7, 1, v6
    v_min_u32 v7, 2047, v7
    v_cvt_f32_u32 v8, v7
    v_cvt_pk_bf16_f32 v8, v8, v8
    v_and_b32 v8, 0xffff, v8
    v_subrev_u32 v8, 17024, v8
    v_cmp_gt_u32 vcc, 128, v7
    v_cndmask_b32 v7, v8, v7, vcc
    v_lshrrev_b32 v8, 4, v7
    v_add_u32 v7, v7, v8
    v_lshl_add_u32 v201, v7, 2, s21
    v_subrev_u32 v7, 2, v6
    v_min_u32 v7, 2047, v7
    v_cvt_f32_u32 v8, v7
    v_cvt_pk_bf16_f32 v8, v8, v8
    v_and_b32 v8, 0xffff, v8
    v_subrev_u32 v8, 17024, v8
    v_cmp_gt_u32 vcc, 128, v7
    v_cndmask_b32 v7, v8, v7, vcc
    v_lshrrev_b32 v8, 4, v7
    v_add_u32 v7, v7, v8
    v_lshl_add_u32 v202, v7, 2, s21
    v_subrev_u32 v7, 3, v6
    v_min_u32 v7, 2047, v7
    v_cvt_f32_u32 v8, v7
    v_cvt_pk_bf16_f32 v8, v8, v8
    v_and_b32 v8, 0xffff, v8
    v_subrev_u32 v8, 17024, v8
    v_cmp_gt_u32 vcc, 128, v7
    v_cndmask_b32 v7, v8, v7, vcc
    v_lshrrev_b32 v8, 4, v7
    v_add_u32 v7, v7, v8
    v_lshl_add_u32 v203, v7, 2, s21
    v_subrev_u32 v7, 4, v6
    v_min_u32 v7, 2047, v7
    v_cvt_f32_u32 v8, v7
    v_cvt_pk_bf16_f32 v8, v8, v8
    v_and_b32 v8, 0xffff, v8
    v_subrev_u32 v8, 17024, v8
    v_cmp_gt_u32 vcc, 128, v7
    v_cndmask_b32 v7, v8, v7, vcc
    v_lshrrev_b32 v8, 4, v7
    v_add_u32 v7, v7, v8
    v_lshl_add_u32 v204, v7, 2, s21
    v_subrev_u32 v7, 5, v6
    v_min_u32 v7, 2047, v7
    v_cvt_f32_u32 v8, v7
    v_cvt_pk_bf16_f32 v8, v8, v8
    v_and_b32 v8, 0xffff, v8
    v_subrev_u32 v8, 17024, v8
    v_cmp_gt_u32 vcc, 128, v7
    v_cndmask_b32 v7, v8, v7, vcc
    v_lshrrev_b32 v8, 4, v7
    v_add_u32 v7, v7, v8
    v_lshl_add_u32 v205, v7, 2, s21
    v_subrev_u32 v7, 6, v6
    v_min_u32 v7, 2047, v7
    v_cvt_f32_u32 v8, v7
    v_cvt_pk_bf16_f32 v8, v8, v8
    v_and_b32 v8, 0xffff, v8
    v_subrev_u32 v8, 17024, v8
    v_cmp_gt_u32 vcc, 128, v7
    v_cndmask_b32 v7, v8, v7, vcc
    v_lshrrev_b32 v8, 4, v7
    v_add_u32 v7, v7, v8
    v_lshl_add_u32 v206, v7, 2, s21
    v_subrev_u32 v7, 7, v6
    v_min_u32 v7, 2047, v7
    v_cvt_f32_u32 v8, v7
    v_cvt_pk_bf16_f32 v8, v8, v8
    v_and_b32 v8, 0xffff, v8
    v_subrev_u32 v8, 17024, v8
    v_cmp_gt_u32 vcc, 128, v7
    v_cndmask_b32 v7, v8, v7, vcc
    v_lshrrev_b32 v8, 4, v7
    v_add_u32 v7, v7, v8
    v_lshl_add_u32 v207, v7, 2, s21
    v_subrev_u32 v7, 8, v6
    v_min_u32 v7, 2047, v7
    v_cvt_f32_u32 v8, v7
    v_cvt_pk_bf16_f32 v8, v8, v8
    v_and_b32 v8, 0xffff, v8
    v_subrev_u32 v8, 17024, v8
    v_cmp_gt_u32 vcc, 128, v7
    v_cndmask_b32 v7, v8, v7, vcc
    v_lshrrev_b32 v8, 4, v7
    v_add_u32 v7, v7, v8
    v_lshl_add_u32 v208, v7, 2, s21
    v_subrev_u32 v7, 9, v6
    v_min_u32 v7, 2047, v7
    v_cvt_f32_u32 v8, v7
    v_cvt_pk_bf16_f32 v8, v8, v8
    v_and_b32 v8, 0xffff, v8
    v_subrev_u32 v8, 17024, v8
    v_cmp_gt_u32 vcc, 128, v7
    v_cndmask_b32 v7, v8, v7, vcc
    v_lshrrev_b32 v8, 4, v7
    v_add_u32 v7, v7, v8
    v_lshl_add_u32 v209, v7, 2, s21
    v_subrev_u32 v7, 10, v6
    v_min_u32 v7, 2047, v7
    v_cvt_f32_u32 v8, v7
    v_cvt_pk_bf16_f32 v8, v8, v8
    v_and_b32 v8, 0xffff, v8
    v_subrev_u32 v8, 17024, v8
    v_cmp_gt_u32 vcc, 128, v7
    v_cndmask_b32 v7, v8, v7, vcc
    v_lshrrev_b32 v8, 4, v7
    v_add_u32 v7, v7, v8
    v_lshl_add_u32 v210, v7, 2, s21
    v_subrev_u32 v7, 11, v6
    v_min_u32 v7, 2047, v7
    v_cvt_f32_u32 v8, v7
    v_cvt_pk_bf16_f32 v8, v8, v8
    v_and_b32 v8, 0xffff, v8
    v_subrev_u32 v8, 17024, v8
    v_cmp_gt_u32 vcc, 128, v7
    v_cndmask_b32 v7, v8, v7, vcc
    v_lshrrev_b32 v8, 4, v7
    v_add_u32 v7, v7, v8
    v_lshl_add_u32 v211, v7, 2, s21
    v_subrev_u32 v7, 12, v6
    v_min_u32 v7, 2047, v7
    v_cvt_f32_u32 v8, v7
    v_cvt_pk_bf16_f32 v8, v8, v8
    v_and_b32 v8, 0xffff, v8
    v_subrev_u32 v8, 17024, v8
    v_cmp_gt_u32 vcc, 128, v7
    v_cndmask_b32 v7, v8, v7, vcc
    v_lshrrev_b32 v8, 4, v7
    v_add_u32 v7, v7, v8
    v_lshl_add_u32 v212, v7, 2, s21
    v_subrev_u32 v7, 13, v6
    v_min_u32 v7, 2047, v7
    v_cvt_f32_u32 v8, v7
    v_cvt_pk_bf16_f32 v8, v8, v8
    v_and_b32 v8, 0xffff, v8
    v_subrev_u32 v8, 17024, v8
    v_cmp_gt_u32 vcc, 128, v7
    v_cndmask_b32 v7, v8, v7, vcc
    v_lshrrev_b32 v8, 4, v7
    v_add_u32 v7, v7, v8
    v_lshl_add_u32 v213, v7, 2, s21
    v_subrev_u32 v7, 14, v6
    v_min_u32 v7, 2047, v7
    v_cvt_f32_u32 v8, v7
    v_cvt_pk_bf16_f32 v8, v8, v8
    v_and_b32 v8, 0xffff, v8
    v_subrev_u32 v8, 17024, v8
    v_cmp_gt_u32 vcc, 128, v7
    v_cndmask_b32 v7, v8, v7, vcc
    v_lshrrev_b32 v8, 4, v7
    v_add_u32 v7, v7, v8
    v_lshl_add_u32 v214, v7, 2, s21
    v_subrev_u32 v7, 15, v6
    v_min_u32 v7, 2047, v7
    v_cvt_f32_u32 v8, v7
    v_cvt_pk_bf16_f32 v8, v8, v8
    v_and_b32 v8, 0xffff, v8
    v_subrev_u32 v8, 17024, v8
    v_cmp_gt_u32 vcc, 128, v7
    v_cndmask_b32 v7, v8, v7, vcc
    v_lshrrev_b32 v8, 4, v7
    v_add_u32 v7, v7, v8
    v_lshl_add_u32 v215, v7, 2, s21
    v_subrev_u32 v7, 16, v6
    v_min_u32 v7, 2047, v7
    v_cvt_f32_u32 v8, v7
    v_cvt_pk_bf16_f32 v8, v8, v8
    v_and_b32 v8, 0xffff, v8
    v_subrev_u32 v8, 17024, v8
    v_cmp_gt_u32 vcc, 128, v7
    v_cndmask_b32 v7, v8, v7, vcc
    v_lshrrev_b32 v8, 4, v7
    v_add_u32 v7, v7, v8
    v_lshl_add_u32 v216, v7, 2, s21
    v_subrev_u32 v7, 17, v6
    v_min_u32 v7, 2047, v7
    v_cvt_f32_u32 v8, v7
    v_cvt_pk_bf16_f32 v8, v8, v8
    v_and_b32 v8, 0xffff, v8
    v_subrev_u32 v8, 17024, v8
    v_cmp_gt_u32 vcc, 128, v7
    v_cndmask_b32 v7, v8, v7, vcc
    v_lshrrev_b32 v8, 4, v7
    v_add_u32 v7, v7, v8
    v_lshl_add_u32 v217, v7, 2, s21
    v_subrev_u32 v7, 18, v6
    v_min_u32 v7, 2047, v7
    v_cvt_f32_u32 v8, v7
    v_cvt_pk_bf16_f32 v8, v8, v8
    v_and_b32 v8, 0xffff, v8
    v_subrev_u32 v8, 17024, v8
    v_cmp_gt_u32 vcc, 128, v7
    v_cndmask_b32 v7, v8, v7, vcc
    v_lshrrev_b32 v8, 4, v7
    v_add_u32 v7, v7, v8
    v_lshl_add_u32 v218, v7, 2, s21
    v_subrev_u32 v7, 19, v6
    v_min_u32 v7, 2047, v7
    v_cvt_f32_u32 v8, v7
    v_cvt_pk_bf16_f32 v8, v8, v8
    v_and_b32 v8, 0xffff, v8
    v_subrev_u32 v8, 17024, v8
    v_cmp_gt_u32 vcc, 128, v7
    v_cndmask_b32 v7, v8, v7, vcc
    v_lshrrev_b32 v8, 4, v7
    v_add_u32 v7, v7, v8
    v_lshl_add_u32 v219, v7, 2, s21
    v_subrev_u32 v7, 20, v6
    v_min_u32 v7, 2047, v7
    v_cvt_f32_u32 v8, v7
    v_cvt_pk_bf16_f32 v8, v8, v8
    v_and_b32 v8, 0xffff, v8
    v_subrev_u32 v8, 17024, v8
    v_cmp_gt_u32 vcc, 128, v7
    v_cndmask_b32 v7, v8, v7, vcc
    v_lshrrev_b32 v8, 4, v7
    v_add_u32 v7, v7, v8
    v_lshl_add_u32 v220, v7, 2, s21
    v_subrev_u32 v7, 21, v6
    v_min_u32 v7, 2047, v7
    v_cvt_f32_u32 v8, v7
    v_cvt_pk_bf16_f32 v8, v8, v8
    v_and_b32 v8, 0xffff, v8
    v_subrev_u32 v8, 17024, v8
    v_cmp_gt_u32 vcc, 128, v7
    v_cndmask_b32 v7, v8, v7, vcc
    v_lshrrev_b32 v8, 4, v7
    v_add_u32 v7, v7, v8
    v_lshl_add_u32 v221, v7, 2, s21
    v_subrev_u32 v7, 22, v6
    v_min_u32 v7, 2047, v7
    v_cvt_f32_u32 v8, v7
    v_cvt_pk_bf16_f32 v8, v8, v8
    v_and_b32 v8, 0xffff, v8
    v_subrev_u32 v8, 17024, v8
    v_cmp_gt_u32 vcc, 128, v7
    v_cndmask_b32 v7, v8, v7, vcc
    v_lshrrev_b32 v8, 4, v7
    v_add_u32 v7, v7, v8
    v_lshl_add_u32 v222, v7, 2, s21
    v_subrev_u32 v7, 23, v6
    v_min_u32 v7, 2047, v7
    v_cvt_f32_u32 v8, v7
    v_cvt_pk_bf16_f32 v8, v8, v8
    v_and_b32 v8, 0xffff, v8
    v_subrev_u32 v8, 17024, v8
    v_cmp_gt_u32 vcc, 128, v7
    v_cndmask_b32 v7, v8, v7, vcc
    v_lshrrev_b32 v8, 4, v7
    v_add_u32 v7, v7, v8
    v_lshl_add_u32 v223, v7, 2, s21
    v_subrev_u32 v7, 24, v6
    v_min_u32 v7, 2047, v7
    v_cvt_f32_u32 v8, v7
    v_cvt_pk_bf16_f32 v8, v8, v8
    v_and_b32 v8, 0xffff, v8
    v_subrev_u32 v8, 17024, v8
    v_cmp_gt_u32 vcc, 128, v7
    v_cndmask_b32 v7, v8, v7, vcc
    v_lshrrev_b32 v8, 4, v7
    v_add_u32 v7, v7, v8
    v_lshl_add_u32 v224, v7, 2, s21
    v_subrev_u32 v7, 25, v6
    v_min_u32 v7, 2047, v7
    v_cvt_f32_u32 v8, v7
    v_cvt_pk_bf16_f32 v8, v8, v8
    v_and_b32 v8, 0xffff, v8
    v_subrev_u32 v8, 17024, v8
    v_cmp_gt_u32 vcc, 128, v7
    v_cndmask_b32 v7, v8, v7, vcc
    v_lshrrev_b32 v8, 4, v7
    v_add_u32 v7, v7, v8
    v_lshl_add_u32 v225, v7, 2, s21
    v_subrev_u32 v7, 26, v6
    v_min_u32 v7, 2047, v7
    v_cvt_f32_u32 v8, v7
    v_cvt_pk_bf16_f32 v8, v8, v8
    v_and_b32 v8, 0xffff, v8
    v_subrev_u32 v8, 17024, v8
    v_cmp_gt_u32 vcc, 128, v7
    v_cndmask_b32 v7, v8, v7, vcc
    v_lshrrev_b32 v8, 4, v7
    v_add_u32 v7, v7, v8
    v_lshl_add_u32 v226, v7, 2, s21
    v_subrev_u32 v7, 27, v6
    v_min_u32 v7, 2047, v7
    v_cvt_f32_u32 v8, v7
    v_cvt_pk_bf16_f32 v8, v8, v8
    v_and_b32 v8, 0xffff, v8
    v_subrev_u32 v8, 17024, v8
    v_cmp_gt_u32 vcc, 128, v7
    v_cndmask_b32 v7, v8, v7, vcc
    v_lshrrev_b32 v8, 4, v7
    v_add_u32 v7, v7, v8
    v_lshl_add_u32 v227, v7, 2, s21
    v_subrev_u32 v7, 28, v6
    v_min_u32 v7, 2047, v7
    v_cvt_f32_u32 v8, v7
    v_cvt_pk_bf16_f32 v8, v8, v8
    v_and_b32 v8, 0xffff, v8
    v_subrev_u32 v8, 17024, v8
    v_cmp_gt_u32 vcc, 128, v7
    v_cndmask_b32 v7, v8, v7, vcc
    v_lshrrev_b32 v8, 4, v7
    v_add_u32 v7, v7, v8
    v_lshl_add_u32 v228, v7, 2, s21
    v_subrev_u32 v7, 29, v6
    v_min_u32 v7, 2047, v7
    v_cvt_f32_u32 v8, v7
    v_cvt_pk_bf16_f32 v8, v8, v8
    v_and_b32 v8, 0xffff, v8
    v_subrev_u32 v8, 17024, v8
    v_cmp_gt_u32 vcc, 128, v7
    v_cndmask_b32 v7, v8, v7, vcc
    v_lshrrev_b32 v8, 4, v7
    v_add_u32 v7, v7, v8
    v_lshl_add_u32 v229, v7, 2, s21
    v_subrev_u32 v7, 30, v6
    v_min_u32 v7, 2047, v7
    v_cvt_f32_u32 v8, v7
    v_cvt_pk_bf16_f32 v8, v8, v8
    v_and_b32 v8, 0xffff, v8
    v_subrev_u32 v8, 17024, v8
    v_cmp_gt_u32 vcc, 128, v7
    v_cndmask_b32 v7, v8, v7, vcc
    v_lshrrev_b32 v8, 4, v7
    v_add_u32 v7, v7, v8
    v_lshl_add_u32 v230, v7, 2, s21
    v_subrev_u32 v7, 31, v6
    v_min_u32 v7, 2047, v7
    v_cvt_f32_u32 v8, v7
    v_cvt_pk_bf16_f32 v8, v8, v8
    v_and_b32 v8, 0xffff, v8
    v_subrev_u32 v8, 17024, v8
    v_cmp_gt_u32 vcc, 128, v7
    v_cndmask_b32 v7, v8, v7, vcc
    v_lshrrev_b32 v8, 4, v7
    v_add_u32 v7, v7, v8
    v_lshl_add_u32 v231, v7, 2, s21
    v_subrev_u32 v7, 32, v6
    v_min_u32 v7, 2047, v7
    v_cvt_f32_u32 v8, v7
    v_cvt_pk_bf16_f32 v8, v8, v8
    v_and_b32 v8, 0xffff, v8
    v_subrev_u32 v8, 17024, v8
    v_cmp_gt_u32 vcc, 128, v7
    v_cndmask_b32 v7, v8, v7, vcc
    v_lshrrev_b32 v8, 4, v7
    v_add_u32 v7, v7, v8
    v_lshl_add_u32 v232, v7, 2, s21
    v_subrev_u32 v7, 33, v6
    v_min_u32 v7, 2047, v7
    v_cvt_f32_u32 v8, v7
    v_cvt_pk_bf16_f32 v8, v8, v8
    v_and_b32 v8, 0xffff, v8
    v_subrev_u32 v8, 17024, v8
    v_cmp_gt_u32 vcc, 128, v7
    v_cndmask_b32 v7, v8, v7, vcc
    v_lshrrev_b32 v8, 4, v7
    v_add_u32 v7, v7, v8
    v_lshl_add_u32 v233, v7, 2, s21
    v_subrev_u32 v7, 34, v6
    v_min_u32 v7, 2047, v7
    v_cvt_f32_u32 v8, v7
    v_cvt_pk_bf16_f32 v8, v8, v8
    v_and_b32 v8, 0xffff, v8
    v_subrev_u32 v8, 17024, v8
    v_cmp_gt_u32 vcc, 128, v7
    v_cndmask_b32 v7, v8, v7, vcc
    v_lshrrev_b32 v8, 4, v7
    v_add_u32 v7, v7, v8
    v_lshl_add_u32 v234, v7, 2, s21
    v_lshrrev_b32 v7, 4, v0
    v_and_b32 v8, 15, v0
    v_sub_u32 v9, v7, v8
    v_max_i32 v9, 0, v9
    v_lshl_add_u32 v235, v9, 2, s21
    v_mul_u32_u24 v9, 4160, v7
    v_lshl_add_u32 v9, v8, 1, v9
    s_add_u32 s22, s44, 4096
    v_add_u32 v236, s22, v9
    v_and_b32 v8, 15, v0
    v_lshlrev_b32 v9, 4, v8
    v_cvt_f32_u32 v237, v9
    v_lshlrev_b32 v9, 5, v8
    v_add_u32 v9, 256, v9
    v_lshlrev_b32 v10, 6, v8
    v_cmp_gt_u32 vcc, 8, v8
    v_cndmask_b32 v9, v10, v9, vcc
    v_cvt_f32_u32 v238, v9
    v_lshlrev_b32 v9, 7, v8
    v_add_u32 v9, 1024, v9
    v_cvt_f32_u32 v239, v9
    v_cvt_f32_u32 v240, v8
    s_sub_u32 s40, s39, 160
    s_lshl_b32 s40, s40, 2
    s_load_dwordx4 s[48:51], s[0:1], 64
    s_load_dwordx4 s[52:55], s[0:1], 80
    s_load_dwordx4 s[56:59], s[0:1], 96
    s_load_dwordx4 s[60:63], s[0:1], 112
    s_load_dwordx2 s[64:65], s[0:1], 56
    s_load_dwordx2 s[66:67], s[0:1], 128
    s_waitcnt lgkmcnt(0)
    s_mov_b32 s8, s64
    s_mov_b32 s9, s65
    s_mov_b32 s10, 2359296
    s_mov_b32 s11, 0x00020000
    s_lshl_b32 s21, s20, 6
    v_add_u32 v6, s21, v0
    v_mul_u32_u24 v7, 1152, v6
    s_lshl_b32 s22, s40, 1
    s_add_u32 s23, s22, 0
    buffer_load_dwordx2 v[16:17], v7, s[8:11], s23 offen
    s_add_u32 s23, s22, 294912
    buffer_load_dwordx2 v[18:19], v7, s[8:11], s23 offen
    s_add_u32 s23, s22, 589824
    buffer_load_dwordx2 v[20:21], v7, s[8:11], s23 offen
    s_add_u32 s23, s22, 884736
    buffer_load_dwordx2 v[22:23], v7, s[8:11], s23 offen
    s_add_u32 s23, s22, 1179648
    buffer_load_dwordx2 v[24:25], v7, s[8:11], s23 offen
    s_add_u32 s23, s22, 1474560
    buffer_load_dwordx2 v[26:27], v7, s[8:11], s23 offen
    s_add_u32 s23, s22, 1769472
    buffer_load_dwordx2 v[28:29], v7, s[8:11], s23 offen
    s_add_u32 s23, s22, 2064384
    buffer_load_dwordx2 v[30:31], v7, s[8:11], s23 offen
    s_add_u32 s45, s40, s20
    s_lshl_b32 s22, s45, 8
    v_lshlrev_b32 v8, 1, v0
    s_mov_b32 s12, s48
    s_mov_b32 s13, s49
    s_mov_b32 s14, 147456
    s_mov_b32 s15, 0x00020000
    buffer_load_ushort v32, v8, s[12:15], s22 offen
    buffer_load_ushort v33, v8, s[12:15], s22 offen offset:128
    s_mov_b32 s12, s50
    s_mov_b32 s13, s51
    s_mov_b32 s14, 147456
    s_mov_b32 s15, 0x00020000
    buffer_load_ushort v34, v8, s[12:15], s22 offen
    buffer_load_ushort v35, v8, s[12:15], s22 offen offset:128
    s_mov_b32 s12, s52
    s_mov_b32 s13, s53
    s_mov_b32 s14, 147456
    s_mov_b32 s15, 0x00020000
    buffer_load_ushort v36, v8, s[12:15], s22 offen
    buffer_load_ushort v37, v8, s[12:15], s22 offen offset:128
    s_mov_b32 s12, s54
    s_mov_b32 s13, s55
    s_mov_b32 s14, 147456
    s_mov_b32 s15, 0x00020000
    buffer_load_ushort v38, v8, s[12:15], s22 offen
    buffer_load_ushort v39, v8, s[12:15], s22 offen offset:128
    s_mov_b32 s12, s56
    s_mov_b32 s13, s57
    s_mov_b32 s14, 147456
    s_mov_b32 s15, 0x00020000
    buffer_load_ushort v40, v8, s[12:15], s22 offen
    buffer_load_ushort v41, v8, s[12:15], s22 offen offset:128
    s_mov_b32 s12, s58
    s_mov_b32 s13, s59
    s_mov_b32 s14, 147456
    s_mov_b32 s15, 0x00020000
    buffer_load_ushort v42, v8, s[12:15], s22 offen
    buffer_load_ushort v43, v8, s[12:15], s22 offen offset:128
    s_lshl_b32 s22, s45, 1
    v_mov_b32 v9, 0
    s_mov_b32 s12, s60
    s_mov_b32 s13, s61
    s_mov_b32 s14, 1152
    s_mov_b32 s15, 0x00020000
    buffer_load_ushort v44, v9, s[12:15], s22 offen
    s_mov_b32 s12, s62
    s_mov_b32 s13, s63
    s_mov_b32 s14, 1152
    s_mov_b32 s15, 0x00020000
    buffer_load_ushort v45, v9, s[12:15], s22 offen
    v_mov_b32 v10, 0
    v_mov_b32 v11, 0
    s_mul_i32 s23, s20, 4608
    s_add_u32 s46, s23, 88064
    v_lshlrev_b32 v12, 3, v0
    v_add_u32 v12, s46, v12
    ds_write_b64 v12, v[10:11]
    s_waitcnt vmcnt(14)
    v_lshlrev_b32 v12, 1, v6
    v_add_u32 v12, 88576, v12
    ds_write_b16 v12, v16 offset:0
    ds_write_b16_d16_hi v12, v16 offset:4608
    ds_write_b16 v12, v17 offset:9216
    ds_write_b16_d16_hi v12, v17 offset:13824
    ds_write_b16 v12, v18 offset:512
    ds_write_b16_d16_hi v12, v18 offset:5120
    ds_write_b16 v12, v19 offset:9728
    ds_write_b16_d16_hi v12, v19 offset:14336
    ds_write_b16 v12, v20 offset:1024
    ds_write_b16_d16_hi v12, v20 offset:5632
    ds_write_b16 v12, v21 offset:10240
    ds_write_b16_d16_hi v12, v21 offset:14848
    ds_write_b16 v12, v22 offset:1536
    ds_write_b16_d16_hi v12, v22 offset:6144
    ds_write_b16 v12, v23 offset:10752
    ds_write_b16_d16_hi v12, v23 offset:15360
    ds_write_b16 v12, v24 offset:2048
    ds_write_b16_d16_hi v12, v24 offset:6656
    ds_write_b16 v12, v25 offset:11264
    ds_write_b16_d16_hi v12, v25 offset:15872
    ds_write_b16 v12, v26 offset:2560
    ds_write_b16_d16_hi v12, v26 offset:7168
    ds_write_b16 v12, v27 offset:11776
    ds_write_b16_d16_hi v12, v27 offset:16384
    ds_write_b16 v12, v28 offset:3072
    ds_write_b16_d16_hi v12, v28 offset:7680
    ds_write_b16 v12, v29 offset:12288
    ds_write_b16_d16_hi v12, v29 offset:16896
    ds_write_b16 v12, v30 offset:3584
    ds_write_b16_d16_hi v12, v30 offset:8192
    ds_write_b16 v12, v31 offset:12800
    ds_write_b16_d16_hi v12, v31 offset:17408
    s_waitcnt vmcnt(0)
    v_lshlrev_b32 v32, 16, v32
    v_lshlrev_b32 v33, 16, v33
    v_lshlrev_b32 v34, 16, v34
    v_lshlrev_b32 v35, 16, v35
    v_lshlrev_b32 v36, 16, v36
    v_lshlrev_b32 v37, 16, v37
    v_lshlrev_b32 v38, 16, v38
    v_lshlrev_b32 v39, 16, v39
    v_lshlrev_b32 v40, 16, v40
    v_lshlrev_b32 v41, 16, v41
    v_lshlrev_b32 v42, 16, v42
    v_lshlrev_b32 v43, 16, v43
    v_lshlrev_b32 v44, 16, v44
    v_lshlrev_b32 v45, 16, v45
    s_mov_b32 s21, 0x3fb8aa3b
    v_mul_f32 v44, s21, v44
    v_exp_f32 v44, v44
    s_nop 0
    v_cvt_pk_bf16_f32 v44, v44, v44
    v_lshlrev_b32 v44, 16, v44
    s_mov_b32 s22, 0x3e22f983
    s_add_u32 s23, s44, 16640
    v_lshl_add_u32 v12, v0, 4, s23
    v_mul_f32 v48, v44, v32
    v_mul_f32 v48, s21, v48
    v_mul_f32 v49, v44, v34
    v_mul_f32 v49, s22, v49
    v_mul_f32 v52, v44, v36
    v_mul_f32 v53, v44, v38
    v_mul_f32 v50, v40, v52
    v_fma_f32 v50, -v42, v53, v50
    v_mul_f32 v51, v40, v53
    v_fma_f32 v51, v42, v52, v51
    ds_write_b128 v12, v[48:51] offset:0
    v_mul_f32 v48, v44, v33
    v_mul_f32 v48, s21, v48
    v_mul_f32 v49, v44, v35
    v_mul_f32 v49, s22, v49
    v_mul_f32 v52, v44, v37
    v_mul_f32 v53, v44, v39
    v_mul_f32 v50, v41, v52
    v_fma_f32 v50, -v43, v53, v50
    v_mul_f32 v51, v41, v53
    v_fma_f32 v51, v43, v52, v51
    ds_write_b128 v12, v[48:51] offset:1024
    v_mov_b32 v241, v45
    v_lshrrev_b32 v1, 4, v0
    v_lshl_add_u32 v1, v1, 6, s23
    v_mov_b32 v44, 0
    v_mov_b32 v45, 0
    v_mov_b32 v46, 0
    v_mov_b32 v47, 0
    v_mov_b32 v48, 0
    v_mov_b32 v49, 0
    v_mov_b32 v50, 0
    v_mov_b32 v51, 0
    v_mov_b32 v52, 0
    v_mov_b32 v53, 0
    v_mov_b32 v54, 0
    v_mov_b32 v55, 0
    v_mov_b32 v56, 0
    v_mov_b32 v57, 0
    v_mov_b32 v58, 0
    v_mov_b32 v59, 0
    s_waitcnt lgkmcnt(0)
    s_mov_b32 s24, 0
SK_51:
    ds_read_b128 v[60:63], v1 offset:0
    ds_read_b128 v[64:67], v1 offset:16
    ds_read_b128 v[68:71], v1 offset:32
    ds_read_b128 v[72:75], v1 offset:48
    v_add_u32 v1, 256, v1
    s_waitcnt lgkmcnt(0)
    v_mul_f32 v80, v60, v237
    v_mul_f32 v84, v61, v237
    v_mul_f32 v81, v60, v238
    v_mul_f32 v85, v61, v238
    v_mul_f32 v82, v60, v239
    v_mul_f32 v86, v61, v239
    v_mul_f32 v83, v60, v240
    v_mul_f32 v87, v61, v240
    v_exp_f32 v80, v80
    v_fract_f32 v84, v84
    v_exp_f32 v81, v81
    v_fract_f32 v85, v85
    v_exp_f32 v82, v82
    v_fract_f32 v86, v86
    v_exp_f32 v83, v83
    v_fract_f32 v87, v87
    v_sin_f32 v88, v84
    v_cos_f32 v92, v84
    v_sin_f32 v89, v85
    v_cos_f32 v93, v85
    v_sin_f32 v90, v86
    v_cos_f32 v94, v86
    v_sin_f32 v91, v87
    v_cos_f32 v95, v87
    s_nop 0
    v_mul_f32 v96, v92, v62
    v_mul_f32 v97, v92, v63
    v_fma_f32 v96, -v88, v63, v96
    v_fma_f32 v97, v88, v62, v97
    v_mul_f32 v96, v80, v96
    v_mul_f32_e64 v97, -v80, v97
    v_cvt_pk_bf16_f32 v16, v96, v97
    v_mul_f32 v96, v93, v62
    v_mul_f32 v97, v93, v63
    v_fma_f32 v96, -v89, v63, v96
    v_fma_f32 v97, v89, v62, v97
    v_mul_f32 v96, v81, v96
    v_mul_f32_e64 v97, -v81, v97
    v_cvt_pk_bf16_f32 v20, v96, v97
    v_mul_f32 v96, v94, v62
    v_mul_f32 v97, v94, v63
    v_fma_f32 v96, -v90, v63, v96
    v_fma_f32 v97, v90, v62, v97
    v_mul_f32 v96, v82, v96
    v_mul_f32_e64 v97, -v82, v97
    v_cvt_pk_bf16_f32 v24, v96, v97
    v_mul_f32 v96, v83, v95
    v_mul_f32 v97, v83, v91
    v_cvt_pk_bf16_f32 v28, v96, v97
    v_mul_f32 v98, v96, v96
    v_mul_f32 v99, v96, v97
    v_fma_f32 v96, -v97, v97, v98
    v_add_f32 v97, v99, v99
    v_cvt_pk_bf16_f32 v32, v96, v97
    v_mul_f32 v98, v96, v96
    v_mul_f32 v99, v96, v97
    v_fma_f32 v96, -v97, v97, v98
    v_add_f32 v97, v99, v99
    v_cvt_pk_bf16_f32 v36, v96, v97
    v_mul_f32 v98, v96, v96
    v_mul_f32 v99, v96, v97
    v_fma_f32 v96, -v97, v97, v98
    v_add_f32 v97, v99, v99
    v_cvt_pk_bf16_f32 v40, v96, v97
    v_mul_f32 v80, v64, v237
    v_mul_f32 v84, v65, v237
    v_mul_f32 v81, v64, v238
    v_mul_f32 v85, v65, v238
    v_mul_f32 v82, v64, v239
    v_mul_f32 v86, v65, v239
    v_mul_f32 v83, v64, v240
    v_mul_f32 v87, v65, v240
    v_exp_f32 v80, v80
    v_fract_f32 v84, v84
    v_exp_f32 v81, v81
    v_fract_f32 v85, v85
    v_exp_f32 v82, v82
    v_fract_f32 v86, v86
    v_exp_f32 v83, v83
    v_fract_f32 v87, v87
    v_sin_f32 v88, v84
    v_cos_f32 v92, v84
    v_sin_f32 v89, v85
    v_cos_f32 v93, v85
    v_sin_f32 v90, v86
    v_cos_f32 v94, v86
    v_sin_f32 v91, v87
    v_cos_f32 v95, v87
    s_nop 0
    v_mul_f32 v96, v92, v66
    v_mul_f32 v97, v92, v67
    v_fma_f32 v96, -v88, v67, v96
    v_fma_f32 v97, v88, v66, v97
    v_mul_f32 v96, v80, v96
    v_mul_f32_e64 v97, -v80, v97
    v_cvt_pk_bf16_f32 v17, v96, v97
    v_mul_f32 v96, v93, v66
    v_mul_f32 v97, v93, v67
    v_fma_f32 v96, -v89, v67, v96
    v_fma_f32 v97, v89, v66, v97
    v_mul_f32 v96, v81, v96
    v_mul_f32_e64 v97, -v81, v97
    v_cvt_pk_bf16_f32 v21, v96, v97
    v_mul_f32 v96, v94, v66
    v_mul_f32 v97, v94, v67
    v_fma_f32 v96, -v90, v67, v96
    v_fma_f32 v97, v90, v66, v97
    v_mul_f32 v96, v82, v96
    v_mul_f32_e64 v97, -v82, v97
    v_cvt_pk_bf16_f32 v25, v96, v97
    v_mul_f32 v96, v83, v95
    v_mul_f32 v97, v83, v91
    v_cvt_pk_bf16_f32 v29, v96, v97
    v_mul_f32 v98, v96, v96
    v_mul_f32 v99, v96, v97
    v_fma_f32 v96, -v97, v97, v98
    v_add_f32 v97, v99, v99
    v_cvt_pk_bf16_f32 v33, v96, v97
    v_mul_f32 v98, v96, v96
    v_mul_f32 v99, v96, v97
    v_fma_f32 v96, -v97, v97, v98
    v_add_f32 v97, v99, v99
    v_cvt_pk_bf16_f32 v37, v96, v97
    v_mul_f32 v98, v96, v96
    v_mul_f32 v99, v96, v97
    v_fma_f32 v96, -v97, v97, v98
    v_add_f32 v97, v99, v99
    v_cvt_pk_bf16_f32 v41, v96, v97
    v_mul_f32 v80, v68, v237
    v_mul_f32 v84, v69, v237
    v_mul_f32 v81, v68, v238
    v_mul_f32 v85, v69, v238
    v_mul_f32 v82, v68, v239
    v_mul_f32 v86, v69, v239
    v_mul_f32 v83, v68, v240
    v_mul_f32 v87, v69, v240
    v_exp_f32 v80, v80
    v_fract_f32 v84, v84
    v_exp_f32 v81, v81
    v_fract_f32 v85, v85
    v_exp_f32 v82, v82
    v_fract_f32 v86, v86
    v_exp_f32 v83, v83
    v_fract_f32 v87, v87
    v_sin_f32 v88, v84
    v_cos_f32 v92, v84
    v_sin_f32 v89, v85
    v_cos_f32 v93, v85
    v_sin_f32 v90, v86
    v_cos_f32 v94, v86
    v_sin_f32 v91, v87
    v_cos_f32 v95, v87
    s_nop 0
    v_mul_f32 v96, v92, v70
    v_mul_f32 v97, v92, v71
    v_fma_f32 v96, -v88, v71, v96
    v_fma_f32 v97, v88, v70, v97
    v_mul_f32 v96, v80, v96
    v_mul_f32_e64 v97, -v80, v97
    v_cvt_pk_bf16_f32 v18, v96, v97
    v_mul_f32 v96, v93, v70
    v_mul_f32 v97, v93, v71
    v_fma_f32 v96, -v89, v71, v96
    v_fma_f32 v97, v89, v70, v97
    v_mul_f32 v96, v81, v96
    v_mul_f32_e64 v97, -v81, v97
    v_cvt_pk_bf16_f32 v22, v96, v97
    v_mul_f32 v96, v94, v70
    v_mul_f32 v97, v94, v71
    v_fma_f32 v96, -v90, v71, v96
    v_fma_f32 v97, v90, v70, v97
    v_mul_f32 v96, v82, v96
    v_mul_f32_e64 v97, -v82, v97
    v_cvt_pk_bf16_f32 v26, v96, v97
    v_mul_f32 v96, v83, v95
    v_mul_f32 v97, v83, v91
    v_cvt_pk_bf16_f32 v30, v96, v97
    v_mul_f32 v98, v96, v96
    v_mul_f32 v99, v96, v97
    v_fma_f32 v96, -v97, v97, v98
    v_add_f32 v97, v99, v99
    v_cvt_pk_bf16_f32 v34, v96, v97
    v_mul_f32 v98, v96, v96
    v_mul_f32 v99, v96, v97
    v_fma_f32 v96, -v97, v97, v98
    v_add_f32 v97, v99, v99
    v_cvt_pk_bf16_f32 v38, v96, v97
    v_mul_f32 v98, v96, v96
    v_mul_f32 v99, v96, v97
    v_fma_f32 v96, -v97, v97, v98
    v_add_f32 v97, v99, v99
    v_cvt_pk_bf16_f32 v42, v96, v97
    v_mul_f32 v80, v72, v237
    v_mul_f32 v84, v73, v237
    v_mul_f32 v81, v72, v238
    v_mul_f32 v85, v73, v238
    v_mul_f32 v82, v72, v239
    v_mul_f32 v86, v73, v239
    v_mul_f32 v83, v72, v240
    v_mul_f32 v87, v73, v240
    v_exp_f32 v80, v80
    v_fract_f32 v84, v84
    v_exp_f32 v81, v81
    v_fract_f32 v85, v85
    v_exp_f32 v82, v82
    v_fract_f32 v86, v86
    v_exp_f32 v83, v83
    v_fract_f32 v87, v87
    v_sin_f32 v88, v84
    v_cos_f32 v92, v84
    v_sin_f32 v89, v85
    v_cos_f32 v93, v85
    v_sin_f32 v90, v86
    v_cos_f32 v94, v86
    v_sin_f32 v91, v87
    v_cos_f32 v95, v87
    s_nop 0
    v_mul_f32 v96, v92, v74
    v_mul_f32 v97, v92, v75
    v_fma_f32 v96, -v88, v75, v96
    v_fma_f32 v97, v88, v74, v97
    v_mul_f32 v96, v80, v96
    v_mul_f32_e64 v97, -v80, v97
    v_cvt_pk_bf16_f32 v19, v96, v97
    v_mul_f32 v96, v93, v74
    v_mul_f32 v97, v93, v75
    v_fma_f32 v96, -v89, v75, v96
    v_fma_f32 v97, v89, v74, v97
    v_mul_f32 v96, v81, v96
    v_mul_f32_e64 v97, -v81, v97
    v_cvt_pk_bf16_f32 v23, v96, v97
    v_mul_f32 v96, v94, v74
    v_mul_f32 v97, v94, v75
    v_fma_f32 v96, -v90, v75, v96
    v_fma_f32 v97, v90, v74, v97
    v_mul_f32 v96, v82, v96
    v_mul_f32_e64 v97, -v82, v97
    v_cvt_pk_bf16_f32 v27, v96, v97
    v_mul_f32 v96, v83, v95
    v_mul_f32 v97, v83, v91
    v_cvt_pk_bf16_f32 v31, v96, v97
    v_mul_f32 v98, v96, v96
    v_mul_f32 v99, v96, v97
    v_fma_f32 v96, -v97, v97, v98
    v_add_f32 v97, v99, v99
    v_cvt_pk_bf16_f32 v35, v96, v97
    v_mul_f32 v98, v96, v96
    v_mul_f32 v99, v96, v97
    v_fma_f32 v96, -v97, v97, v98
    v_add_f32 v97, v99, v99
    v_cvt_pk_bf16_f32 v39, v96, v97
    v_mul_f32 v98, v96, v96
    v_mul_f32 v99, v96, v97
    v_fma_f32 v96, -v97, v97, v98
    v_add_f32 v97, v99, v99
    v_cvt_pk_bf16_f32 v43, v96, v97
    s_nop 1
    v_mfma_f32_16x16x32_bf16 v[44:47], v[16:19], v[28:31], v[44:47]
    v_mfma_f32_16x16x32_bf16 v[48:51], v[20:23], v[32:35], v[48:51]
    v_mfma_f32_16x16x32_bf16 v[52:55], v[20:23], v[36:39], v[52:55]
    v_mfma_f32_16x16x32_bf16 v[56:59], v[24:27], v[40:43], v[56:59]
    s_add_u32 s24, s24, 1
    s_cmp_lt_u32 s24, 8
    s_cbranch_scc1 SK_51
    s_nop 7
    s_nop 1
    v_lshrrev_b32 v6, 4, v0
    v_cmp_gt_u32 vcc, 2, v6
    v_cndmask_b32 v48, v52, v48, vcc
    v_cndmask_b32 v49, v53, v49, vcc
    v_cndmask_b32 v50, v54, v50, vcc
    v_cndmask_b32 v51, v55, v51, vcc
    v_mul_u32_u24 v6, 68, v6
    v_and_b32 v7, 15, v0
    v_add_u32 v6, v6, v7
    s_add_u32 s21, s44, 18688
    v_lshl_add_u32 v6, v6, 2, s21
    ds_write_b32 v6, v44 offset:0
    ds_write_b32 v6, v45 offset:68
    ds_write_b32 v6, v46 offset:136
    ds_write_b32 v6, v47 offset:204
    ds_write_b32 v6, v48 offset:1088
    ds_write_b32 v6, v49 offset:1156
    ds_write_b32 v6, v50 offset:1224
    ds_write_b32 v6, v51 offset:1292
    ds_write_b32 v6, v56 offset:2176
    ds_write_b32 v6, v57 offset:2244
    ds_write_b32 v6, v58 offset:2312
    ds_write_b32 v6, v59 offset:2380
    s_waitcnt lgkmcnt(0)
    ds_read_b32 v100, v200
    ds_read_b32 v101, v201
    ds_read_b32 v102, v202
    ds_read_b32 v103, v203
    ds_read_b32 v104, v204
    ds_read_b32 v105, v205
    ds_read_b32 v106, v206
    ds_read_b32 v107, v207
    ds_read_b32 v108, v208
    ds_read_b32 v109, v209
    ds_read_b32 v110, v210
    ds_read_b32 v111, v211
    ds_read_b32 v112, v212
    ds_read_b32 v113, v213
    ds_read_b32 v114, v214
    ds_read_b32 v115, v215
    ds_read_b32 v116, v216
    ds_read_b32 v117, v217
    ds_read_b32 v118, v218
    ds_read_b32 v119, v219
    ds_read_b32 v120, v220
    ds_read_b32 v121, v221
    ds_read_b32 v122, v222
    ds_read_b32 v123, v223
    ds_read_b32 v124, v224
    ds_read_b32 v125, v225
    ds_read_b32 v126, v226
    ds_read_b32 v127, v227
    ds_read_b32 v128, v228
    ds_read_b32 v129, v229
    ds_read_b32 v130, v230
    ds_read_b32 v131, v231
    ds_read_b32 v132, v232
    ds_read_b32 v133, v233
    ds_read_b32 v134, v234
    ds_read_b32 v135, v235
    s_waitcnt lgkmcnt(0)
    v_cvt_pk_bf16_f32 v140, v100, v101
    v_cvt_pk_bf16_f32 v141, v102, v103
    v_cvt_pk_bf16_f32 v142, v104, v105
    v_cvt_pk_bf16_f32 v143, v106, v107
    v_cvt_pk_bf16_f32 v144, v108, v109
    v_cvt_pk_bf16_f32 v145, v110, v111
    v_cvt_pk_bf16_f32 v146, v112, v113
    v_cvt_pk_bf16_f32 v147, v114, v115
    v_cvt_pk_bf16_f32 v148, v116, v117
    v_cvt_pk_bf16_f32 v149, v118, v119
    v_cvt_pk_bf16_f32 v150, v120, v121
    v_cvt_pk_bf16_f32 v151, v122, v123
    v_cvt_pk_bf16_f32 v152, v124, v125
    v_cvt_pk_bf16_f32 v153, v126, v127
    v_cvt_pk_bf16_f32 v154, v128, v129
    v_cvt_pk_bf16_f32 v155, v130, v131
    v_cvt_pk_bf16_f32 v156, v132, v133
    v_cvt_pk_bf16_f32 v160, v101, v102
    v_cvt_pk_bf16_f32 v161, v103, v104
    v_cvt_pk_bf16_f32 v162, v105, v106
    v_cvt_pk_bf16_f32 v163, v107, v108
    v_cvt_pk_bf16_f32 v164, v109, v110
    v_cvt_pk_bf16_f32 v165, v111, v112
    v_cvt_pk_bf16_f32 v166, v113, v114
    v_cvt_pk_bf16_f32 v167, v115, v116
    v_cvt_pk_bf16_f32 v168, v117, v118
    v_cvt_pk_bf16_f32 v169, v119, v120
    v_cvt_pk_bf16_f32 v170, v121, v122
    v_cvt_pk_bf16_f32 v171, v123, v124
    v_cvt_pk_bf16_f32 v172, v125, v126
    v_cvt_pk_bf16_f32 v173, v127, v128
    v_cvt_pk_bf16_f32 v174, v129, v130
    v_cvt_pk_bf16_f32 v175, v131, v132
    v_cvt_pk_bf16_f32 v176, v133, v134
    v_lshl_add_u32 v6, v0, 6, s44
    ds_write_b128 v6, v[140:143] offset:12480
    ds_write_b128 v6, v[144:147] offset:12496
    ds_write_b128 v6, v[148:151] offset:12512
    ds_write_b128 v6, v[152:155] offset:12528
    ds_write_b128 v6, v[160:163] offset:8320
    ds_write_b128 v6, v[164:167] offset:8336
    ds_write_b128 v6, v[168:171] offset:8352
    ds_write_b128 v6, v[172:175] offset:8368
    v_mov_b32 v100, v141
    v_mov_b32 v101, v142
    v_mov_b32 v102, v143
    v_mov_b32 v103, v144
    v_mov_b32 v104, v145
    v_mov_b32 v105, v146
    v_mov_b32 v106, v147
    v_mov_b32 v107, v148
    v_mov_b32 v108, v149
    v_mov_b32 v109, v150
    v_mov_b32 v110, v151
    v_mov_b32 v111, v152
    v_mov_b32 v112, v153
    v_mov_b32 v113, v154
    v_mov_b32 v114, v155
    v_mov_b32 v115, v156
    ds_write_b128 v6, v[100:103] offset:4160
    ds_write_b128 v6, v[104:107] offset:4176
    ds_write_b128 v6, v[108:111] offset:4192
    ds_write_b128 v6, v[112:115] offset:4208
    s_waitcnt lgkmcnt(0)
    v_mov_b32 v100, v161
    v_mov_b32 v101, v162
    v_mov_b32 v102, v163
    v_mov_b32 v103, v164
    v_mov_b32 v104, v165
    v_mov_b32 v105, v166
    v_mov_b32 v106, v167
    v_mov_b32 v107, v168
    v_mov_b32 v108, v169
    v_mov_b32 v109, v170
    v_mov_b32 v110, v171
    v_mov_b32 v111, v172
    v_mov_b32 v112, v173
    v_mov_b32 v113, v174
    v_mov_b32 v114, v175
    v_mov_b32 v115, v176
    ds_write_b128 v6, v[100:103] offset:0
    ds_write_b128 v6, v[104:107] offset:16
    ds_write_b128 v6, v[108:111] offset:32
    ds_write_b128 v6, v[112:115] offset:48
    v_lshrrev_b32 v7, 4, v0
    v_and_b32 v8, 15, v0
    v_cmp_le_u32 vcc, v8, v7
    v_cndmask_b32 v135, 0, v135, vcc
    v_cvt_pk_bf16_f32 v135, v135, v135
    ds_write_b16 v236, v135
    s_waitcnt lgkmcnt(0)
    s_barrier
    v_and_b32 v6, 3, v0
    v_mul_u32_u24 v6, 4160, v6
    v_lshrrev_b32 v7, 4, v0
    v_lshl_add_u32 v6, v7, 4, v6
    v_bfe_u32 v8, v0, 2, 2
    v_lshlrev_b32 v8, 3, v8
    v_sub_u32 v6, v6, v8
    s_add_u32 s21, s44, 480
    v_add_u32 v6, s21, v6
    v_and_b32 v8, 15, v0
    v_lshlrev_b32 v8, 5, v8
    v_lshl_add_u32 v8, v7, 4, v8
    s_add_u32 s21, s46, 480
    v_add_u32 v7, s21, v8
    v_mov_b32 v16, 0
    v_mov_b32 v17, 0
    v_mov_b32 v18, 0
    v_mov_b32 v19, 0
    v_mov_b32 v20, 0
    v_mov_b32 v21, 0
    v_mov_b32 v22, 0
    v_mov_b32 v23, 0
    v_mov_b32 v24, 0
    v_mov_b32 v25, 0
    v_mov_b32 v26, 0
    v_mov_b32 v27, 0
    v_mov_b32 v28, 0
    v_mov_b32 v29, 0
    v_mov_b32 v30, 0
    v_mov_b32 v31, 0
    v_mov_b32 v32, 0
    v_mov_b32 v33, 0
    v_mov_b32 v34, 0
    v_mov_b32 v35, 0
    v_mov_b32 v36, 0
    v_mov_b32 v37, 0
    v_mov_b32 v38, 0
    v_mov_b32 v39, 0
    v_mov_b32 v40, 0
    v_mov_b32 v41, 0
    v_mov_b32 v42, 0
    v_mov_b32 v43, 0
    v_mov_b32 v44, 0
    v_mov_b32 v45, 0
    v_mov_b32 v46, 0
    v_mov_b32 v47, 0
    ds_read_b64 v[48:49], v6 offset:3584
    ds_read_b64 v[50:51], v6 offset:3592
    ds_read_b64 v[52:53], v6 offset:3072
    ds_read_b64 v[54:55], v6 offset:3080
    ds_read_b64 v[56:57], v6 offset:2560
    ds_read_b64 v[58:59], v6 offset:2568
    ds_read_b64 v[60:61], v6 offset:2048
    ds_read_b64 v[62:63], v6 offset:2056
    ds_read_b64 v[64:65], v6 offset:1536
    ds_read_b64 v[66:67], v6 offset:1544
    ds_read_b64 v[68:69], v6 offset:1024
    ds_read_b64 v[70:71], v6 offset:1032
    ds_read_b64 v[72:73], v6 offset:512
    ds_read_b64 v[74:75], v6 offset:520
    ds_read_b64 v[76:77], v6 offset:0
    ds_read_b64 v[78:79], v6 offset:8
    ds_read_b128 v[80:83], v7 offset:0
    ds_read_b128 v[84:87], v7 offset:512
    ds_read_b128 v[88:91], v7 offset:1024
    ds_read_b128 v[92:95], v7 offset:1536
    ds_read_b128 v[96:99], v7 offset:2048
    ds_read_b128 v[100:103], v7 offset:2560
    ds_read_b128 v[104:107], v7 offset:3072
    ds_read_b128 v[108:111], v7 offset:3584
    v_subrev_u32 v6, 64, v6
    v_subrev_u32 v7, 64, v7
    s_mov_b32 s24, 0
SC_52:
    s_waitcnt lgkmcnt(0)
    ds_read_b64 v[112:113], v6 offset:3584
    ds_read_b64 v[114:115], v6 offset:3592
    ds_read_b64 v[116:117], v6 offset:3072
    ds_read_b64 v[118:119], v6 offset:3080
    ds_read_b64 v[120:121], v6 offset:2560
    ds_read_b64 v[122:123], v6 offset:2568
    ds_read_b64 v[124:125], v6 offset:2048
    ds_read_b64 v[126:127], v6 offset:2056
    ds_read_b64 v[128:129], v6 offset:1536
    ds_read_b64 v[130:131], v6 offset:1544
    ds_read_b64 v[132:133], v6 offset:1024
    ds_read_b64 v[134:135], v6 offset:1032
    ds_read_b64 v[136:137], v6 offset:512
    ds_read_b64 v[138:139], v6 offset:520
    ds_read_b64 v[140:141], v6 offset:0
    ds_read_b64 v[142:143], v6 offset:8
    ds_read_b128 v[144:147], v7 offset:0
    ds_read_b128 v[148:151], v7 offset:512
    ds_read_b128 v[152:155], v7 offset:1024
    ds_read_b128 v[156:159], v7 offset:1536
    ds_read_b128 v[160:163], v7 offset:2048
    ds_read_b128 v[164:167], v7 offset:2560
    ds_read_b128 v[168:171], v7 offset:3072
    ds_read_b128 v[172:175], v7 offset:3584
    v_subrev_u32 v6, 64, v6
    v_subrev_u32 v7, 64, v7
    v_mfma_f32_16x16x32_bf16 v[16:19], v[48:51], v[80:83], v[16:19]
    v_mfma_f32_16x16x32_bf16 v[20:23], v[52:55], v[80:83], v[20:23]
    v_mfma_f32_16x16x32_bf16 v[24:27], v[56:59], v[80:83], v[24:27]
    v_mfma_f32_16x16x32_bf16 v[28:31], v[60:63], v[80:83], v[28:31]
    v_mfma_f32_16x16x32_bf16 v[32:35], v[64:67], v[80:83], v[32:35]
    v_mfma_f32_16x16x32_bf16 v[36:39], v[68:71], v[80:83], v[36:39]
    v_mfma_f32_16x16x32_bf16 v[40:43], v[72:75], v[80:83], v[40:43]
    v_mfma_f32_16x16x32_bf16 v[44:47], v[76:79], v[80:83], v[44:47]
    v_mfma_f32_16x16x32_bf16 v[20:23], v[48:51], v[84:87], v[20:23]
    v_mfma_f32_16x16x32_bf16 v[24:27], v[52:55], v[84:87], v[24:27]
    v_mfma_f32_16x16x32_bf16 v[28:31], v[56:59], v[84:87], v[28:31]
    v_mfma_f32_16x16x32_bf16 v[32:35], v[60:63], v[84:87], v[32:35]
    v_mfma_f32_16x16x32_bf16 v[36:39], v[64:67], v[84:87], v[36:39]
    v_mfma_f32_16x16x32_bf16 v[40:43], v[68:71], v[84:87], v[40:43]
    v_mfma_f32_16x16x32_bf16 v[44:47], v[72:75], v[84:87], v[44:47]
    v_mfma_f32_16x16x32_bf16 v[24:27], v[48:51], v[88:91], v[24:27]
    v_mfma_f32_16x16x32_bf16 v[28:31], v[52:55], v[88:91], v[28:31]
    v_mfma_f32_16x16x32_bf16 v[32:35], v[56:59], v[88:91], v[32:35]
    v_mfma_f32_16x16x32_bf16 v[36:39], v[60:63], v[88:91], v[36:39]
    v_mfma_f32_16x16x32_bf16 v[40:43], v[64:67], v[88:91], v[40:43]
    v_mfma_f32_16x16x32_bf16 v[44:47], v[68:71], v[88:91], v[44:47]
    v_mfma_f32_16x16x32_bf16 v[28:31], v[48:51], v[92:95], v[28:31]
    v_mfma_f32_16x16x32_bf16 v[32:35], v[52:55], v[92:95], v[32:35]
    v_mfma_f32_16x16x32_bf16 v[36:39], v[56:59], v[92:95], v[36:39]
    v_mfma_f32_16x16x32_bf16 v[40:43], v[60:63], v[92:95], v[40:43]
    v_mfma_f32_16x16x32_bf16 v[44:47], v[64:67], v[92:95], v[44:47]
    v_mfma_f32_16x16x32_bf16 v[32:35], v[48:51], v[96:99], v[32:35]
    v_mfma_f32_16x16x32_bf16 v[36:39], v[52:55], v[96:99], v[36:39]
    v_mfma_f32_16x16x32_bf16 v[40:43], v[56:59], v[96:99], v[40:43]
    v_mfma_f32_16x16x32_bf16 v[44:47], v[60:63], v[96:99], v[44:47]
    v_mfma_f32_16x16x32_bf16 v[36:39], v[48:51], v[100:103], v[36:39]
    v_mfma_f32_16x16x32_bf16 v[40:43], v[52:55], v[100:103], v[40:43]
    v_mfma_f32_16x16x32_bf16 v[44:47], v[56:59], v[100:103], v[44:47]
    v_mfma_f32_16x16x32_bf16 v[40:43], v[48:51], v[104:107], v[40:43]
    v_mfma_f32_16x16x32_bf16 v[44:47], v[52:55], v[104:107], v[44:47]
    v_mfma_f32_16x16x32_bf16 v[44:47], v[48:51], v[108:111], v[44:47]
    s_waitcnt lgkmcnt(0)
    ds_read_b64 v[48:49], v6 offset:3584
    ds_read_b64 v[50:51], v6 offset:3592
    ds_read_b64 v[52:53], v6 offset:3072
    ds_read_b64 v[54:55], v6 offset:3080
    ds_read_b64 v[56:57], v6 offset:2560
    ds_read_b64 v[58:59], v6 offset:2568
    ds_read_b64 v[60:61], v6 offset:2048
    ds_read_b64 v[62:63], v6 offset:2056
    ds_read_b64 v[64:65], v6 offset:1536
    ds_read_b64 v[66:67], v6 offset:1544
    ds_read_b64 v[68:69], v6 offset:1024
    ds_read_b64 v[70:71], v6 offset:1032
    ds_read_b64 v[72:73], v6 offset:512
    ds_read_b64 v[74:75], v6 offset:520
    ds_read_b64 v[76:77], v6 offset:0
    ds_read_b64 v[78:79], v6 offset:8
    ds_read_b128 v[80:83], v7 offset:0
    ds_read_b128 v[84:87], v7 offset:512
    ds_read_b128 v[88:91], v7 offset:1024
    ds_read_b128 v[92:95], v7 offset:1536
    ds_read_b128 v[96:99], v7 offset:2048
    ds_read_b128 v[100:103], v7 offset:2560
    ds_read_b128 v[104:107], v7 offset:3072
    ds_read_b128 v[108:111], v7 offset:3584
    v_subrev_u32 v6, 64, v6
    v_subrev_u32 v7, 64, v7
    v_mfma_f32_16x16x32_bf16 v[16:19], v[112:115], v[144:147], v[16:19]
    v_mfma_f32_16x16x32_bf16 v[20:23], v[116:119], v[144:147], v[20:23]
    v_mfma_f32_16x16x32_bf16 v[24:27], v[120:123], v[144:147], v[24:27]
    v_mfma_f32_16x16x32_bf16 v[28:31], v[124:127], v[144:147], v[28:31]
    v_mfma_f32_16x16x32_bf16 v[32:35], v[128:131], v[144:147], v[32:35]
    v_mfma_f32_16x16x32_bf16 v[36:39], v[132:135], v[144:147], v[36:39]
    v_mfma_f32_16x16x32_bf16 v[40:43], v[136:139], v[144:147], v[40:43]
    v_mfma_f32_16x16x32_bf16 v[44:47], v[140:143], v[144:147], v[44:47]
    v_mfma_f32_16x16x32_bf16 v[20:23], v[112:115], v[148:151], v[20:23]
    v_mfma_f32_16x16x32_bf16 v[24:27], v[116:119], v[148:151], v[24:27]
    v_mfma_f32_16x16x32_bf16 v[28:31], v[120:123], v[148:151], v[28:31]
    v_mfma_f32_16x16x32_bf16 v[32:35], v[124:127], v[148:151], v[32:35]
    v_mfma_f32_16x16x32_bf16 v[36:39], v[128:131], v[148:151], v[36:39]
    v_mfma_f32_16x16x32_bf16 v[40:43], v[132:135], v[148:151], v[40:43]
    v_mfma_f32_16x16x32_bf16 v[44:47], v[136:139], v[148:151], v[44:47]
    v_mfma_f32_16x16x32_bf16 v[24:27], v[112:115], v[152:155], v[24:27]
    v_mfma_f32_16x16x32_bf16 v[28:31], v[116:119], v[152:155], v[28:31]
    v_mfma_f32_16x16x32_bf16 v[32:35], v[120:123], v[152:155], v[32:35]
    v_mfma_f32_16x16x32_bf16 v[36:39], v[124:127], v[152:155], v[36:39]
    v_mfma_f32_16x16x32_bf16 v[40:43], v[128:131], v[152:155], v[40:43]
    v_mfma_f32_16x16x32_bf16 v[44:47], v[132:135], v[152:155], v[44:47]
    v_mfma_f32_16x16x32_bf16 v[28:31], v[112:115], v[156:159], v[28:31]
    v_mfma_f32_16x16x32_bf16 v[32:35], v[116:119], v[156:159], v[32:35]
    v_mfma_f32_16x16x32_bf16 v[36:39], v[120:123], v[156:159], v[36:39]
    v_mfma_f32_16x16x32_bf16 v[40:43], v[124:127], v[156:159], v[40:43]
    v_mfma_f32_16x16x32_bf16 v[44:47], v[128:131], v[156:159], v[44:47]
    v_mfma_f32_16x16x32_bf16 v[32:35], v[112:115], v[160:163], v[32:35]
    v_mfma_f32_16x16x32_bf16 v[36:39], v[116:119], v[160:163], v[36:39]
    v_mfma_f32_16x16x32_bf16 v[40:43], v[120:123], v[160:163], v[40:43]
    v_mfma_f32_16x16x32_bf16 v[44:47], v[124:127], v[160:163], v[44:47]
    v_mfma_f32_16x16x32_bf16 v[36:39], v[112:115], v[164:167], v[36:39]
    v_mfma_f32_16x16x32_bf16 v[40:43], v[116:119], v[164:167], v[40:43]
    v_mfma_f32_16x16x32_bf16 v[44:47], v[120:123], v[164:167], v[44:47]
    v_mfma_f32_16x16x32_bf16 v[40:43], v[112:115], v[168:171], v[40:43]
    v_mfma_f32_16x16x32_bf16 v[44:47], v[116:119], v[168:171], v[44:47]
    v_mfma_f32_16x16x32_bf16 v[44:47], v[112:115], v[172:175], v[44:47]
    s_add_u32 s24, s24, 1
    s_cmp_lt_u32 s24, 4
    s_cbranch_scc1 SC_52
    s_waitcnt lgkmcnt(0)
    v_and_b32 v8, 15, v0
    v_lshlrev_b32 v8, 5, v8
    v_lshrrev_b32 v9, 4, v0
    v_lshl_add_u32 v8, v9, 3, v8
    s_add_u32 s21, s46, 512
    v_add_u32 v6, s21, v8
    v_add_u32 v7, s44, v8
    ds_read_b64 v[48:49], v6 offset:0
    ds_read_b64 v[50:51], v6 offset:512
    ds_read_b64 v[52:53], v6 offset:1024
    ds_read_b64 v[54:55], v6 offset:1536
    ds_read_b64 v[56:57], v6 offset:2048
    ds_read_b64 v[58:59], v6 offset:2560
    ds_read_b64 v[60:61], v6 offset:3072
    ds_read_b64 v[62:63], v6 offset:3584
    s_waitcnt lgkmcnt(0)
    v_cvt_pk_bf16_f32 v16, v16, v17
    v_cvt_pk_bf16_f32 v17, v18, v19
    v_lshlrev_b32 v64, 16, v48
    v_and_b32 v65, 0xffff0000, v48
    v_lshlrev_b32 v66, 16, v49
    v_and_b32 v67, 0xffff0000, v49
    v_mul_f32 v64, v64, v241
    v_mul_f32 v65, v65, v241
    v_mul_f32 v66, v66, v241
    v_mul_f32 v67, v67, v241
    v_cvt_pk_bf16_f32 v64, v64, v65
    v_cvt_pk_bf16_f32 v65, v66, v67
    v_lshlrev_b32 v68, 16, v64
    v_and_b32 v69, 0xffff0000, v64
    v_lshlrev_b32 v70, 16, v65
    v_and_b32 v71, 0xffff0000, v65
    v_lshlrev_b32 v72, 16, v16
    v_and_b32 v73, 0xffff0000, v16
    v_lshlrev_b32 v74, 16, v17
    v_and_b32 v75, 0xffff0000, v17
    v_add_f32 v68, v68, v72
    v_add_f32 v69, v69, v73
    v_add_f32 v70, v70, v74
    v_add_f32 v71, v71, v75
    v_cvt_pk_bf16_f32 v16, v68, v69
    v_cvt_pk_bf16_f32 v17, v70, v71
    ds_write_b64 v7, v[16:17] offset:0
    v_cvt_pk_bf16_f32 v20, v20, v21
    v_cvt_pk_bf16_f32 v21, v22, v23
    v_lshlrev_b32 v64, 16, v50
    v_and_b32 v65, 0xffff0000, v50
    v_lshlrev_b32 v66, 16, v51
    v_and_b32 v67, 0xffff0000, v51
    v_mul_f32 v64, v64, v241
    v_mul_f32 v65, v65, v241
    v_mul_f32 v66, v66, v241
    v_mul_f32 v67, v67, v241
    v_cvt_pk_bf16_f32 v64, v64, v65
    v_cvt_pk_bf16_f32 v65, v66, v67
    v_lshlrev_b32 v68, 16, v64
    v_and_b32 v69, 0xffff0000, v64
    v_lshlrev_b32 v70, 16, v65
    v_and_b32 v71, 0xffff0000, v65
    v_lshlrev_b32 v72, 16, v20
    v_and_b32 v73, 0xffff0000, v20
    v_lshlrev_b32 v74, 16, v21
    v_and_b32 v75, 0xffff0000, v21
    v_add_f32 v68, v68, v72
    v_add_f32 v69, v69, v73
    v_add_f32 v70, v70, v74
    v_add_f32 v71, v71, v75
    v_cvt_pk_bf16_f32 v20, v68, v69
    v_cvt_pk_bf16_f32 v21, v70, v71
    ds_write_b64 v7, v[20:21] offset:512
    v_cvt_pk_bf16_f32 v24, v24, v25
    v_cvt_pk_bf16_f32 v25, v26, v27
    v_lshlrev_b32 v64, 16, v52
    v_and_b32 v65, 0xffff0000, v52
    v_lshlrev_b32 v66, 16, v53
    v_and_b32 v67, 0xffff0000, v53
    v_mul_f32 v64, v64, v241
    v_mul_f32 v65, v65, v241
    v_mul_f32 v66, v66, v241
    v_mul_f32 v67, v67, v241
    v_cvt_pk_bf16_f32 v64, v64, v65
    v_cvt_pk_bf16_f32 v65, v66, v67
    v_lshlrev_b32 v68, 16, v64
    v_and_b32 v69, 0xffff0000, v64
    v_lshlrev_b32 v70, 16, v65
    v_and_b32 v71, 0xffff0000, v65
    v_lshlrev_b32 v72, 16, v24
    v_and_b32 v73, 0xffff0000, v24
    v_lshlrev_b32 v74, 16, v25
    v_and_b32 v75, 0xffff0000, v25
    v_add_f32 v68, v68, v72
    v_add_f32 v69, v69, v73
    v_add_f32 v70, v70, v74
    v_add_f32 v71, v71, v75
    v_cvt_pk_bf16_f32 v24, v68, v69
    v_cvt_pk_bf16_f32 v25, v70, v71
    ds_write_b64 v7, v[24:25] offset:1024
    v_cvt_pk_bf16_f32 v28, v28, v29
    v_cvt_pk_bf16_f32 v29, v30, v31
    v_lshlrev_b32 v64, 16, v54
    v_and_b32 v65, 0xffff0000, v54
    v_lshlrev_b32 v66, 16, v55
    v_and_b32 v67, 0xffff0000, v55
    v_mul_f32 v64, v64, v241
    v_mul_f32 v65, v65, v241
    v_mul_f32 v66, v66, v241
    v_mul_f32 v67, v67, v241
    v_cvt_pk_bf16_f32 v64, v64, v65
    v_cvt_pk_bf16_f32 v65, v66, v67
    v_lshlrev_b32 v68, 16, v64
    v_and_b32 v69, 0xffff0000, v64
    v_lshlrev_b32 v70, 16, v65
    v_and_b32 v71, 0xffff0000, v65
    v_lshlrev_b32 v72, 16, v28
    v_and_b32 v73, 0xffff0000, v28
    v_lshlrev_b32 v74, 16, v29
    v_and_b32 v75, 0xffff0000, v29
    v_add_f32 v68, v68, v72
    v_add_f32 v69, v69, v73
    v_add_f32 v70, v70, v74
    v_add_f32 v71, v71, v75
    v_cvt_pk_bf16_f32 v28, v68, v69
    v_cvt_pk_bf16_f32 v29, v70, v71
    ds_write_b64 v7, v[28:29] offset:1536
    v_cvt_pk_bf16_f32 v32, v32, v33
    v_cvt_pk_bf16_f32 v33, v34, v35
    v_lshlrev_b32 v64, 16, v56
    v_and_b32 v65, 0xffff0000, v56
    v_lshlrev_b32 v66, 16, v57
    v_and_b32 v67, 0xffff0000, v57
    v_mul_f32 v64, v64, v241
    v_mul_f32 v65, v65, v241
    v_mul_f32 v66, v66, v241
    v_mul_f32 v67, v67, v241
    v_cvt_pk_bf16_f32 v64, v64, v65
    v_cvt_pk_bf16_f32 v65, v66, v67
    v_lshlrev_b32 v68, 16, v64
    v_and_b32 v69, 0xffff0000, v64
    v_lshlrev_b32 v70, 16, v65
    v_and_b32 v71, 0xffff0000, v65
    v_lshlrev_b32 v72, 16, v32
    v_and_b32 v73, 0xffff0000, v32
    v_lshlrev_b32 v74, 16, v33
    v_and_b32 v75, 0xffff0000, v33
    v_add_f32 v68, v68, v72
    v_add_f32 v69, v69, v73
    v_add_f32 v70, v70, v74
    v_add_f32 v71, v71, v75
    v_cvt_pk_bf16_f32 v32, v68, v69
    v_cvt_pk_bf16_f32 v33, v70, v71
    ds_write_b64 v7, v[32:33] offset:2048
    v_cvt_pk_bf16_f32 v36, v36, v37
    v_cvt_pk_bf16_f32 v37, v38, v39
    v_lshlrev_b32 v64, 16, v58
    v_and_b32 v65, 0xffff0000, v58
    v_lshlrev_b32 v66, 16, v59
    v_and_b32 v67, 0xffff0000, v59
    v_mul_f32 v64, v64, v241
    v_mul_f32 v65, v65, v241
    v_mul_f32 v66, v66, v241
    v_mul_f32 v67, v67, v241
    v_cvt_pk_bf16_f32 v64, v64, v65
    v_cvt_pk_bf16_f32 v65, v66, v67
    v_lshlrev_b32 v68, 16, v64
    v_and_b32 v69, 0xffff0000, v64
    v_lshlrev_b32 v70, 16, v65
    v_and_b32 v71, 0xffff0000, v65
    v_lshlrev_b32 v72, 16, v36
    v_and_b32 v73, 0xffff0000, v36
    v_lshlrev_b32 v74, 16, v37
    v_and_b32 v75, 0xffff0000, v37
    v_add_f32 v68, v68, v72
    v_add_f32 v69, v69, v73
    v_add_f32 v70, v70, v74
    v_add_f32 v71, v71, v75
    v_cvt_pk_bf16_f32 v36, v68, v69
    v_cvt_pk_bf16_f32 v37, v70, v71
    ds_write_b64 v7, v[36:37] offset:2560
    v_cvt_pk_bf16_f32 v40, v40, v41
    v_cvt_pk_bf16_f32 v41, v42, v43
    v_lshlrev_b32 v64, 16, v60
    v_and_b32 v65, 0xffff0000, v60
    v_lshlrev_b32 v66, 16, v61
    v_and_b32 v67, 0xffff0000, v61
    v_mul_f32 v64, v64, v241
    v_mul_f32 v65, v65, v241
    v_mul_f32 v66, v66, v241
    v_mul_f32 v67, v67, v241
    v_cvt_pk_bf16_f32 v64, v64, v65
    v_cvt_pk_bf16_f32 v65, v66, v67
    v_lshlrev_b32 v68, 16, v64
    v_and_b32 v69, 0xffff0000, v64
    v_lshlrev_b32 v70, 16, v65
    v_and_b32 v71, 0xffff0000, v65
    v_lshlrev_b32 v72, 16, v40
    v_and_b32 v73, 0xffff0000, v40
    v_lshlrev_b32 v74, 16, v41
    v_and_b32 v75, 0xffff0000, v41
    v_add_f32 v68, v68, v72
    v_add_f32 v69, v69, v73
    v_add_f32 v70, v70, v74
    v_add_f32 v71, v71, v75
    v_cvt_pk_bf16_f32 v40, v68, v69
    v_cvt_pk_bf16_f32 v41, v70, v71
    ds_write_b64 v7, v[40:41] offset:3072
    v_cvt_pk_bf16_f32 v44, v44, v45
    v_cvt_pk_bf16_f32 v45, v46, v47
    v_lshlrev_b32 v64, 16, v62
    v_and_b32 v65, 0xffff0000, v62
    v_lshlrev_b32 v66, 16, v63
    v_and_b32 v67, 0xffff0000, v63
    v_mul_f32 v64, v64, v241
    v_mul_f32 v65, v65, v241
    v_mul_f32 v66, v66, v241
    v_mul_f32 v67, v67, v241
    v_cvt_pk_bf16_f32 v64, v64, v65
    v_cvt_pk_bf16_f32 v65, v66, v67
    v_lshlrev_b32 v68, 16, v64
    v_and_b32 v69, 0xffff0000, v64
    v_lshlrev_b32 v70, 16, v65
    v_and_b32 v71, 0xffff0000, v65
    v_lshlrev_b32 v72, 16, v44
    v_and_b32 v73, 0xffff0000, v44
    v_lshlrev_b32 v74, 16, v45
    v_and_b32 v75, 0xffff0000, v45
    v_add_f32 v68, v68, v72
    v_add_f32 v69, v69, v73
    v_add_f32 v70, v70, v74
    v_add_f32 v71, v71, v75
    v_cvt_pk_bf16_f32 v44, v68, v69
    v_cvt_pk_bf16_f32 v45, v70, v71
    ds_write_b64 v7, v[44:45] offset:3584
    s_waitcnt lgkmcnt(0)
    s_barrier
    s_mov_b32 s8, s66
    s_mov_b32 s9, s67
    s_mov_b32 s10, 4718592
    s_mov_b32 s11, 0x00020000
    s_lshl_b32 s21, s20, 6
    v_add_u32 v6, s21, v0
    v_lshlrev_b32 v7, 1, v6
    v_add_u32 v9, 44032, v7
    ds_read_u16 v16, v7 offset:0
    ds_read_u16 v17, v7 offset:22016
    ds_read_u16 v18, v9 offset:0
    ds_read_u16 v19, v9 offset:22016
    ds_read_u16 v20, v7 offset:512
    ds_read_u16 v21, v7 offset:22528
    ds_read_u16 v22, v9 offset:512
    ds_read_u16 v23, v9 offset:22528
    ds_read_u16 v24, v7 offset:1024
    ds_read_u16 v25, v7 offset:23040
    ds_read_u16 v26, v9 offset:1024
    ds_read_u16 v27, v9 offset:23040
    ds_read_u16 v28, v7 offset:1536
    ds_read_u16 v29, v7 offset:23552
    ds_read_u16 v30, v9 offset:1536
    ds_read_u16 v31, v9 offset:23552
    ds_read_u16 v32, v7 offset:2048
    ds_read_u16 v33, v7 offset:24064
    ds_read_u16 v34, v9 offset:2048
    ds_read_u16 v35, v9 offset:24064
    ds_read_u16 v36, v7 offset:2560
    ds_read_u16 v37, v7 offset:24576
    ds_read_u16 v38, v9 offset:2560
    ds_read_u16 v39, v9 offset:24576
    ds_read_u16 v40, v7 offset:3072
    ds_read_u16 v41, v7 offset:25088
    ds_read_u16 v42, v9 offset:3072
    ds_read_u16 v43, v9 offset:25088
    ds_read_u16 v44, v7 offset:3584
    ds_read_u16 v45, v7 offset:25600
    ds_read_u16 v46, v9 offset:3584
    ds_read_u16 v47, v9 offset:25600
    v_mul_u32_u24 v8, 2304, v6
    s_lshl_b32 s22, s40, 1
    s_add_u32 s22, s22, 1152
    s_waitcnt lgkmcnt(0)
    v_lshl_or_b32 v16, v17, 16, v16
    v_lshl_or_b32 v17, v19, 16, v18
    s_add_u32 s23, s22, 0
    buffer_store_dwordx2 v[16:17], v8, s[8:11], s23 offen
    v_lshl_or_b32 v20, v21, 16, v20
    v_lshl_or_b32 v21, v23, 16, v22
    s_add_u32 s23, s22, 589824
    buffer_store_dwordx2 v[20:21], v8, s[8:11], s23 offen
    v_lshl_or_b32 v24, v25, 16, v24
    v_lshl_or_b32 v25, v27, 16, v26
    s_add_u32 s23, s22, 1179648
    buffer_store_dwordx2 v[24:25], v8, s[8:11], s23 offen
    v_lshl_or_b32 v28, v29, 16, v28
    v_lshl_or_b32 v29, v31, 16, v30
    s_add_u32 s23, s22, 1769472
    buffer_store_dwordx2 v[28:29], v8, s[8:11], s23 offen
    v_lshl_or_b32 v32, v33, 16, v32
    v_lshl_or_b32 v33, v35, 16, v34
    s_add_u32 s23, s22, 2359296
    buffer_store_dwordx2 v[32:33], v8, s[8:11], s23 offen
    v_lshl_or_b32 v36, v37, 16, v36
    v_lshl_or_b32 v37, v39, 16, v38
    s_add_u32 s23, s22, 2949120
    buffer_store_dwordx2 v[36:37], v8, s[8:11], s23 offen
    v_lshl_or_b32 v40, v41, 16, v40
    v_lshl_or_b32 v41, v43, 16, v42
    s_add_u32 s23, s22, 3538944
    buffer_store_dwordx2 v[40:41], v8, s[8:11], s23 offen
    v_lshl_or_b32 v44, v45, 16, v44
    v_lshl_or_b32 v45, v47, 16, v46
    s_add_u32 s23, s22, 4128768
    buffer_store_dwordx2 v[44:45], v8, s[8:11], s23 offen
    s_waitcnt vmcnt(0)
    s_barrier
    s_branch M_WORK
M_D2:
    s_sub_u32 s39, s39, 304
    s_cmp_ge_u32 s39, 1118
    s_cbranch_scc1 M_END
    s_cmp_eq_u32 s98, 1
    s_cbranch_scc1 GT_53
    s_load_dwordx2 s[4:5], s[0:1], 136
    s_waitcnt lgkmcnt(0)
    s_mov_b32 s28, s4
    s_mov_b32 s29, s5
    s_mov_b32 s30, 256
    s_mov_b32 s31, 0x00020000
    v_and_b32 v5, 1, v0
    v_mul_u32_u24 v6, 24, v5
    v_sub_u32 v5, 64, v6
    v_and_b32 v7, 1, v0
    v_lshlrev_b32 v7, 5, v7
    v_add_u32 v7, 32, v7
    s_mov_b32 s38, 40000
PL_54:
    buffer_load_dword v6, v5, s[28:31], 0 offen sc1
    s_waitcnt vmcnt(0)
    v_cmp_gt_u32 vcc, v7, v6
    s_cmp_eq_u64 vcc, 0
    s_cbranch_scc1 PK_55
    s_sleep 6
    s_sub_u32 s38, s38, 1
    s_cmp_gt_i32 s38, 0
    s_cbranch_scc1 PL_54
PK_55:
    s_mov_b32 s98, 1
GT_53:
    s_cmp_ge_u32 s39, 638
    s_cbranch_scc1 M_D3
    s_mul_i32 s40, s39, 2979
    s_lshr_b32 s40, s40, 16
    s_mul_i32 s41, s40, 22
    s_sub_u32 s41, s39, s41
    s_cmp_ge_u32 s41, 16
    s_cbranch_scc1 M_WO
    s_lshl_b32 s40, s40, 4
    s_add_u32 s40, s40, s41
    s_branch M_ATT
M_D3:
    s_sub_u32 s39, s39, 638
    s_cmp_ge_u32 s39, 480
    s_cbranch_scc1 M_END
    s_mul_i32 s40, s39, 820
    s_lshr_b32 s40, s40, 16
    s_mul_i32 s41, s40, 80
    s_sub_u32 s41, s39, s41
    s_add_u32 s40, s40, 58
    s_cmp_ge_u32 s41, 8
    s_cbranch_scc1 M_FINE
    s_lshl_b32 s40, s40, 3
    s_add_u32 s40, s40, s41
M_ATT:
    s_lshl_b32 s41, s40, 2
    s_add_u32 s41, s41, s20
    s_and_b32 s42, s41, 31
    s_lshr_b32 s43, s41, 5
    v_and_b32 v5, 1, v0
    v_lshlrev_b32 v5, 12, v5
    s_lshl_b32 s21, s42, 7
    s_add_u32 s21, s21, 8192
    v_add_u32 v5, s21, v5
    s_mov_b32 s38, 40000
PL_56:
    buffer_load_dword v6, v5, s[32:35], 0 offen sc1
    s_waitcnt vmcnt(0)
    v_cmp_ge_u32 vcc, s43, v6
    s_cmp_eq_u64 vcc, 0
    s_cbranch_scc1 PK_57
    s_sleep 6
    s_sub_u32 s38, s38, 1
    s_cmp_gt_i32 s38, 0
    s_cbranch_scc1 PL_56
PK_57:
    s_add_u32 s8, s6, 0
    s_addc_u32 s9, s7, 0
    s_mov_b32 s10, 16777216
    s_mov_b32 s11, 0x00020000
    s_add_u32 s12, s6, 16777216
    s_addc_u32 s13, s7, 0
    s_mov_b32 s14, 16777216
    s_mov_b32 s15, 0x00020000
    s_add_u32 s16, s6, 33554432
    s_addc_u32 s17, s7, 0
    s_mov_b32 s18, 16777216
    s_mov_b32 s19, 0x00020000
    s_add_u32 s24, s6, 67108864
    s_addc_u32 s25, s7, 0
    s_mov_b32 s26, 16777216
    s_mov_b32 s27, 0x00020000
    s_add_u32 s28, s6, 50331648
    s_addc_u32 s29, s7, 0
    s_mov_b32 s30, 16777216
    s_mov_b32 s31, 0x00020000
    v_lshlrev_b32 v1, 4, v0
    v_lshrrev_b32 v4, 1, v1
    v_and_b32 v2, 15, v0
    v_lshrrev_b32 v3, 4, v0
    v_lshlrev_b32 v3, 2, v3
    v_sub_u32 v2, v2, v3
    s_lshl_b32 s21, s41, 13
    buffer_load_dwordx4 v[32:35], v1, s[8:11], s21 offen offset:0 sc1
    buffer_load_dwordx4 v[64:67], v1, s[12:15], s21 offen offset:0 sc1
    buffer_load_dwordx4 v[36:39], v1, s[8:11], s21 offen offset:1024 sc1
    buffer_load_dwordx4 v[68:71], v1, s[12:15], s21 offen offset:1024 sc1
    buffer_load_dwordx4 v[40:43], v1, s[8:11], s21 offen offset:2048 sc1
    buffer_load_dwordx4 v[72:75], v1, s[12:15], s21 offen offset:2048 sc1
    buffer_load_dwordx4 v[44:47], v1, s[8:11], s21 offen offset:3072 sc1
    buffer_load_dwordx4 v[76:79], v1, s[12:15], s21 offen offset:3072 sc1
    s_add_u32 s22, s21, 4096
    buffer_load_dwordx4 v[48:51], v1, s[8:11], s22 offen offset:0 sc1
    buffer_load_dwordx4 v[80:83], v1, s[12:15], s22 offen offset:0 sc1
    buffer_load_dwordx4 v[52:55], v1, s[8:11], s22 offen offset:1024 sc1
    buffer_load_dwordx4 v[84:87], v1, s[12:15], s22 offen offset:1024 sc1
    buffer_load_dwordx4 v[56:59], v1, s[8:11], s22 offen offset:2048 sc1
    buffer_load_dwordx4 v[88:91], v1, s[12:15], s22 offen offset:2048 sc1
    buffer_load_dwordx4 v[60:63], v1, s[8:11], s22 offen offset:3072 sc1
    buffer_load_dwordx4 v[92:95], v1, s[12:15], s22 offen offset:3072 sc1
    buffer_load_dwordx4 v[128:131], v1, s[24:27], s21 offen offset:0 sc1
    buffer_load_dwordx4 v[132:135], v1, s[24:27], s21 offen offset:1024 sc1
    buffer_load_dwordx4 v[136:139], v1, s[24:27], s21 offen offset:2048 sc1
    buffer_load_dwordx4 v[140:143], v1, s[24:27], s21 offen offset:3072 sc1
    buffer_load_dwordx4 v[96:99], v1, s[16:19], s21 offen offset:0 sc1
    buffer_load_dwordx4 v[100:103], v1, s[16:19], s21 offen offset:1024 sc1
    buffer_load_dwordx4 v[104:107], v1, s[16:19], s21 offen offset:2048 sc1
    buffer_load_dwordx4 v[108:111], v1, s[16:19], s21 offen offset:3072 sc1
    buffer_load_dwordx4 v[112:115], v1, s[16:19], s22 offen offset:0 sc1
    buffer_load_dwordx4 v[116:119], v1, s[16:19], s22 offen offset:1024 sc1
    buffer_load_dwordx4 v[120:123], v1, s[16:19], s22 offen offset:2048 sc1
    buffer_load_dwordx4 v[124:127], v1, s[16:19], s22 offen offset:3072 sc1
    buffer_load_dwordx2 v[144:145], v4, s[24:27], s22 offen offset:0 sc1
    buffer_load_dwordx2 v[146:147], v4, s[24:27], s22 offen offset:512 sc1
    buffer_load_dwordx2 v[148:149], v4, s[24:27], s22 offen offset:1024 sc1
    buffer_load_dwordx2 v[150:151], v4, s[24:27], s22 offen offset:1536 sc1
    buffer_load_dwordx2 v[152:153], v4, s[24:27], s22 offen offset:2048 sc1
    buffer_load_dwordx2 v[154:155], v4, s[24:27], s22 offen offset:2560 sc1
    buffer_load_dwordx2 v[156:157], v4, s[24:27], s22 offen offset:3072 sc1
    buffer_load_dwordx2 v[158:159], v4, s[24:27], s22 offen offset:3584 sc1
    s_waitcnt vmcnt(16)
    v_mfma_f32_16x16x32_bf16 v[8:11], v[64:67], v[32:35], 0
    v_mfma_f32_16x16x32_bf16 v[12:15], v[128:131], v[32:35], 0
    v_mfma_f32_16x16x32_bf16 v[16:19], v[64:67], v[48:51], 0
    v_mfma_f32_16x16x32_bf16 v[20:23], v[80:83], v[48:51], 0
    v_mfma_f32_16x16x32_bf16 v[24:27], v[128:131], v[48:51], 0
    v_mfma_f32_16x16x32_bf16 v[8:11], v[68:71], v[36:39], v[8:11]
    v_mfma_f32_16x16x32_bf16 v[12:15], v[132:135], v[36:39], v[12:15]
    v_mfma_f32_16x16x32_bf16 v[16:19], v[68:71], v[52:55], v[16:19]
    v_mfma_f32_16x16x32_bf16 v[20:23], v[84:87], v[52:55], v[20:23]
    v_mfma_f32_16x16x32_bf16 v[24:27], v[132:135], v[52:55], v[24:27]
    v_mfma_f32_16x16x32_bf16 v[8:11], v[72:75], v[40:43], v[8:11]
    v_mfma_f32_16x16x32_bf16 v[12:15], v[136:139], v[40:43], v[12:15]
    v_mfma_f32_16x16x32_bf16 v[16:19], v[72:75], v[56:59], v[16:19]
    v_mfma_f32_16x16x32_bf16 v[20:23], v[88:91], v[56:59], v[20:23]
    v_mfma_f32_16x16x32_bf16 v[24:27], v[136:139], v[56:59], v[24:27]
    v_mfma_f32_16x16x32_bf16 v[8:11], v[76:79], v[44:47], v[8:11]
    v_mfma_f32_16x16x32_bf16 v[12:15], v[140:143], v[44:47], v[12:15]
    v_mfma_f32_16x16x32_bf16 v[16:19], v[76:79], v[60:63], v[16:19]
    v_mfma_f32_16x16x32_bf16 v[20:23], v[92:95], v[60:63], v[20:23]
    v_mfma_f32_16x16x32_bf16 v[24:27], v[140:143], v[60:63], v[24:27]
    s_mov_b32 s22, 0x3e0293ee
    v_mov_b32 v5, 0xff800000
    s_nop 7
    v_cmp_le_i32 vcc, 0, v2
    v_cndmask_b32 v8, v5, v8, vcc
    v_cmp_le_i32 vcc, 1, v2
    v_cndmask_b32 v9, v5, v9, vcc
    v_cmp_le_i32 vcc, 2, v2
    v_cndmask_b32 v10, v5, v10, vcc
    v_cmp_le_i32 vcc, 3, v2
    v_cndmask_b32 v11, v5, v11, vcc
    v_cmp_le_i32 vcc, 0, v2
    v_cndmask_b32 v20, v5, v20, vcc
    v_cmp_le_i32 vcc, 1, v2
    v_cndmask_b32 v21, v5, v21, vcc
    v_cmp_le_i32 vcc, 2, v2
    v_cndmask_b32 v22, v5, v22, vcc
    v_cmp_le_i32 vcc, 3, v2
    v_cndmask_b32 v23, v5, v23, vcc
    v_max3_f32 v28, v8, v9, v10
    v_max3_f32 v28, v28, v11, v12
    v_max3_f32 v28, v28, v13, v14
    v_max_f32 v28, v28, v15
    v_max3_f32 v29, v16, v17, v18
    v_max3_f32 v29, v29, v19, v20
    v_max3_f32 v29, v29, v21, v22
    v_max3_f32 v29, v29, v23, v24
    v_max3_f32 v29, v29, v25, v26
    v_max_f32 v29, v29, v27
    v_mov_b32 v30, v28
    v_mov_b32 v31, v29
    s_nop 0
    v_permlane32_swap_b32 v28, v30
    v_permlane32_swap_b32 v29, v31
    s_nop 0
    v_max_f32 v28, v28, v30
    v_max_f32 v29, v29, v31
    v_mov_b32 v30, v28
    v_mov_b32 v31, v29
    s_nop 0
    v_permlane16_swap_b32 v28, v30
    v_permlane16_swap_b32 v29, v31
    s_nop 0
    v_max_f32 v28, v28, v30
    v_max_f32 v29, v29, v31
    v_mul_f32 v28, s22, v28
    v_mul_f32 v29, s22, v29
    v_fma_f32 v8, v8, s22, -v28
    v_fma_f32 v9, v9, s22, -v28
    v_fma_f32 v10, v10, s22, -v28
    v_fma_f32 v11, v11, s22, -v28
    v_fma_f32 v12, v12, s22, -v28
    v_fma_f32 v13, v13, s22, -v28
    v_fma_f32 v14, v14, s22, -v28
    v_fma_f32 v15, v15, s22, -v28
    v_fma_f32 v16, v16, s22, -v29
    v_fma_f32 v17, v17, s22, -v29
    v_fma_f32 v18, v18, s22, -v29
    v_fma_f32 v19, v19, s22, -v29
    v_fma_f32 v20, v20, s22, -v29
    v_fma_f32 v21, v21, s22, -v29
    v_fma_f32 v22, v22, s22, -v29
    v_fma_f32 v23, v23, s22, -v29
    v_fma_f32 v24, v24, s22, -v29
    v_fma_f32 v25, v25, s22, -v29
    v_fma_f32 v26, v26, s22, -v29
    v_fma_f32 v27, v27, s22, -v29
    v_exp_f32 v8, v8
    v_exp_f32 v9, v9
    v_exp_f32 v10, v10
    v_exp_f32 v11, v11
    v_exp_f32 v12, v12
    v_exp_f32 v13, v13
    v_exp_f32 v14, v14
    v_exp_f32 v15, v15
    v_exp_f32 v16, v16
    v_exp_f32 v17, v17
    v_exp_f32 v18, v18
    v_exp_f32 v19, v19
    v_exp_f32 v20, v20
    v_exp_f32 v21, v21
    v_exp_f32 v22, v22
    v_exp_f32 v23, v23
    v_exp_f32 v24, v24
    v_exp_f32 v25, v25
    v_exp_f32 v26, v26
    v_exp_f32 v27, v27
    v_add_f32 v28, v12, v13
    v_add_f32 v30, v14, v15
    v_add_f32 v28, v28, v30
    v_mul_f32 v28, 0.5, v28
    v_add_f32 v29, v24, v25
    v_add_f32 v30, v26, v27
    v_add_f32 v29, v29, v30
    v_mul_f32 v29, 0.5, v29
    v_add_f32 v28, v28, v8
    v_add_f32 v28, v28, v9
    v_add_f32 v28, v28, v10
    v_add_f32 v28, v28, v11
    v_add_f32 v29, v29, v16
    v_add_f32 v29, v29, v17
    v_add_f32 v29, v29, v18
    v_add_f32 v29, v29, v19
    v_add_f32 v29, v29, v20
    v_add_f32 v29, v29, v21
    v_add_f32 v29, v29, v22
    v_add_f32 v29, v29, v23
    v_cvt_pk_bf16_f32 v8, v8, v9
    v_cvt_pk_bf16_f32 v9, v10, v11
    v_mov_b32 v10, 0
    v_mov_b32 v11, 0
    v_cvt_pk_bf16_f32 v12, v12, v13
    v_cvt_pk_bf16_f32 v13, v14, v15
    v_cvt_pk_bf16_f32 v16, v16, v17
    v_cvt_pk_bf16_f32 v17, v18, v19
    v_cvt_pk_bf16_f32 v18, v20, v21
    v_cvt_pk_bf16_f32 v19, v22, v23
    v_cvt_pk_bf16_f32 v20, v24, v25
    v_cvt_pk_bf16_f32 v21, v26, v27
    v_mov_b32 v30, v28
    v_mov_b32 v31, v29
    s_nop 0
    v_permlane32_swap_b32 v28, v30
    v_permlane32_swap_b32 v29, v31
    s_nop 0
    v_add_f32 v28, v28, v30
    v_add_f32 v29, v29, v31
    v_mov_b32 v30, v28
    v_mov_b32 v31, v29
    s_nop 0
    v_permlane16_swap_b32 v28, v30
    v_permlane16_swap_b32 v29, v31
    s_nop 0
    v_add_f32 v28, v28, v30
    v_add_f32 v29, v29, v31
    v_rcp_f32 v28, v28
    v_rcp_f32 v29, v29
    s_waitcnt vmcnt(0)
    v_mfma_f32_16x16x32_bf16 v[32:35], v[96:99], v[8:11], 0
    v_mfma_f32_16x16x32_bf16 v[36:39], v[100:103], v[8:11], 0
    v_mfma_f32_16x16x32_bf16 v[40:43], v[104:107], v[8:11], 0
    v_mfma_f32_16x16x32_bf16 v[44:47], v[108:111], v[8:11], 0
    v_mfma_f32_16x16x32_bf16 v[48:51], v[112:115], v[8:11], 0
    v_mfma_f32_16x16x32_bf16 v[52:55], v[116:119], v[8:11], 0
    v_mfma_f32_16x16x32_bf16 v[56:59], v[120:123], v[8:11], 0
    v_mfma_f32_16x16x32_bf16 v[60:63], v[124:127], v[8:11], 0
    v_mfma_f32_16x16x16_bf16 v[32:35], v[144:145], v[12:13], v[32:35]
    v_mfma_f32_16x16x16_bf16 v[36:39], v[146:147], v[12:13], v[36:39]
    v_mfma_f32_16x16x16_bf16 v[40:43], v[148:149], v[12:13], v[40:43]
    v_mfma_f32_16x16x16_bf16 v[44:47], v[150:151], v[12:13], v[44:47]
    v_mfma_f32_16x16x16_bf16 v[48:51], v[152:153], v[12:13], v[48:51]
    v_mfma_f32_16x16x16_bf16 v[52:55], v[154:155], v[12:13], v[52:55]
    v_mfma_f32_16x16x16_bf16 v[56:59], v[156:157], v[12:13], v[56:59]
    v_mfma_f32_16x16x16_bf16 v[60:63], v[158:159], v[12:13], v[60:63]
    v_mfma_f32_16x16x32_bf16 v[64:67], v[96:99], v[16:19], 0
    v_mfma_f32_16x16x32_bf16 v[68:71], v[100:103], v[16:19], 0
    v_mfma_f32_16x16x32_bf16 v[72:75], v[104:107], v[16:19], 0
    v_mfma_f32_16x16x32_bf16 v[76:79], v[108:111], v[16:19], 0
    v_mfma_f32_16x16x32_bf16 v[80:83], v[112:115], v[16:19], 0
    v_mfma_f32_16x16x32_bf16 v[84:87], v[116:119], v[16:19], 0
    v_mfma_f32_16x16x32_bf16 v[88:91], v[120:123], v[16:19], 0
    v_mfma_f32_16x16x32_bf16 v[92:95], v[124:127], v[16:19], 0
    v_mfma_f32_16x16x16_bf16 v[64:67], v[144:145], v[20:21], v[64:67]
    v_mfma_f32_16x16x16_bf16 v[68:71], v[146:147], v[20:21], v[68:71]
    v_mfma_f32_16x16x16_bf16 v[72:75], v[148:149], v[20:21], v[72:75]
    v_mfma_f32_16x16x16_bf16 v[76:79], v[150:151], v[20:21], v[76:79]
    v_mfma_f32_16x16x16_bf16 v[80:83], v[152:153], v[20:21], v[80:83]
    v_mfma_f32_16x16x16_bf16 v[84:87], v[154:155], v[20:21], v[84:87]
    v_mfma_f32_16x16x16_bf16 v[88:91], v[156:157], v[20:21], v[88:91]
    v_mfma_f32_16x16x16_bf16 v[92:95], v[158:159], v[20:21], v[92:95]
    s_lshl_b32 s21, s41, 0
    s_lshr_b32 s21, s41, 5
    s_lshl_b32 s21, s21, 18
    s_and_b32 s23, s41, 31
    s_lshl_b32 s23, s23, 12
    s_add_u32 s21, s21, s23
    s_add_u32 s23, s21, 0x20000
    v_mul_f32 v32, v32, v28
    v_mul_f32 v33, v33, v28
    v_mul_f32 v34, v34, v28
    v_mul_f32 v35, v35, v28
    v_mul_f32 v36, v36, v28
    v_mul_f32 v37, v37, v28
    v_mul_f32 v38, v38, v28
    v_mul_f32 v39, v39, v28
    v_cvt_pk_bf16_f32 v32, v32, v33
    v_cvt_pk_bf16_f32 v33, v34, v35
    v_cvt_pk_bf16_f32 v34, v36, v37
    v_cvt_pk_bf16_f32 v35, v38, v39
    buffer_store_dwordx4 v[32:35], v1, s[28:31], s21 offen offset:0 sc1
    v_mul_f32 v40, v40, v28
    v_mul_f32 v41, v41, v28
    v_mul_f32 v42, v42, v28
    v_mul_f32 v43, v43, v28
    v_mul_f32 v44, v44, v28
    v_mul_f32 v45, v45, v28
    v_mul_f32 v46, v46, v28
    v_mul_f32 v47, v47, v28
    v_cvt_pk_bf16_f32 v40, v40, v41
    v_cvt_pk_bf16_f32 v41, v42, v43
    v_cvt_pk_bf16_f32 v42, v44, v45
    v_cvt_pk_bf16_f32 v43, v46, v47
    buffer_store_dwordx4 v[40:43], v1, s[28:31], s21 offen offset:1024 sc1
    v_mul_f32 v48, v48, v28
    v_mul_f32 v49, v49, v28
    v_mul_f32 v50, v50, v28
    v_mul_f32 v51, v51, v28
    v_mul_f32 v52, v52, v28
    v_mul_f32 v53, v53, v28
    v_mul_f32 v54, v54, v28
    v_mul_f32 v55, v55, v28
    v_cvt_pk_bf16_f32 v48, v48, v49
    v_cvt_pk_bf16_f32 v49, v50, v51
    v_cvt_pk_bf16_f32 v50, v52, v53
    v_cvt_pk_bf16_f32 v51, v54, v55
    buffer_store_dwordx4 v[48:51], v1, s[28:31], s21 offen offset:2048 sc1
    v_mul_f32 v56, v56, v28
    v_mul_f32 v57, v57, v28
    v_mul_f32 v58, v58, v28
    v_mul_f32 v59, v59, v28
    v_mul_f32 v60, v60, v28
    v_mul_f32 v61, v61, v28
    v_mul_f32 v62, v62, v28
    v_mul_f32 v63, v63, v28
    v_cvt_pk_bf16_f32 v56, v56, v57
    v_cvt_pk_bf16_f32 v57, v58, v59
    v_cvt_pk_bf16_f32 v58, v60, v61
    v_cvt_pk_bf16_f32 v59, v62, v63
    buffer_store_dwordx4 v[56:59], v1, s[28:31], s21 offen offset:3072 sc1
    s_nop 7
    v_mul_f32 v64, v64, v29
    v_mul_f32 v65, v65, v29
    v_mul_f32 v66, v66, v29
    v_mul_f32 v67, v67, v29
    v_mul_f32 v68, v68, v29
    v_mul_f32 v69, v69, v29
    v_mul_f32 v70, v70, v29
    v_mul_f32 v71, v71, v29
    v_cvt_pk_bf16_f32 v64, v64, v65
    v_cvt_pk_bf16_f32 v65, v66, v67
    v_cvt_pk_bf16_f32 v66, v68, v69
    v_cvt_pk_bf16_f32 v67, v70, v71
    buffer_store_dwordx4 v[64:67], v1, s[28:31], s23 offen offset:0 sc1
    v_mul_f32 v72, v72, v29
    v_mul_f32 v73, v73, v29
    v_mul_f32 v74, v74, v29
    v_mul_f32 v75, v75, v29
    v_mul_f32 v76, v76, v29
    v_mul_f32 v77, v77, v29
    v_mul_f32 v78, v78, v29
    v_mul_f32 v79, v79, v29
    v_cvt_pk_bf16_f32 v72, v72, v73
    v_cvt_pk_bf16_f32 v73, v74, v75
    v_cvt_pk_bf16_f32 v74, v76, v77
    v_cvt_pk_bf16_f32 v75, v78, v79
    buffer_store_dwordx4 v[72:75], v1, s[28:31], s23 offen offset:1024 sc1
    v_mul_f32 v80, v80, v29
    v_mul_f32 v81, v81, v29
    v_mul_f32 v82, v82, v29
    v_mul_f32 v83, v83, v29
    v_mul_f32 v84, v84, v29
    v_mul_f32 v85, v85, v29
    v_mul_f32 v86, v86, v29
    v_mul_f32 v87, v87, v29
    v_cvt_pk_bf16_f32 v80, v80, v81
    v_cvt_pk_bf16_f32 v81, v82, v83
    v_cvt_pk_bf16_f32 v82, v84, v85
    v_cvt_pk_bf16_f32 v83, v86, v87
    buffer_store_dwordx4 v[80:83], v1, s[28:31], s23 offen offset:2048 sc1
    v_mul_f32 v88, v88, v29
    v_mul_f32 v89, v89, v29
    v_mul_f32 v90, v90, v29
    v_mul_f32 v91, v91, v29
    v_mul_f32 v92, v92, v29
    v_mul_f32 v93, v93, v29
    v_mul_f32 v94, v94, v29
    v_mul_f32 v95, v95, v29
    v_cvt_pk_bf16_f32 v88, v88, v89
    v_cvt_pk_bf16_f32 v89, v90, v91
    v_cvt_pk_bf16_f32 v90, v92, v93
    v_cvt_pk_bf16_f32 v91, v94, v95
    buffer_store_dwordx4 v[88:91], v1, s[28:31], s23 offen offset:3072 sc1
    s_waitcnt vmcnt(0)
    s_barrier
    s_cmp_lg_u32 s20, 0
    s_cbranch_scc1 M_WORK
    s_lshl_b32 s21, s40, 2
    s_add_u32 s21, s21, 16384
    v_mov_b32 v5, s21
    v_mov_b32 v6, 1
    s_mov_b64 exec, 1
    buffer_store_dword v6, v5, s[32:35], 0 offen sc1
    s_mov_b64 exec, -1
    s_waitcnt vmcnt(0)
    s_branch M_WORK
M_WO:
    s_sub_u32 s41, s41, 16
    s_lshl_b32 s42, s40, 4
    v_and_b32 v5, 15, v0
    v_add_u32 v5, s42, v5
    v_lshlrev_b32 v5, 2, v5
    v_add_u32 v5, 16384, v5
    s_mov_b32 s38, 40000
PL_58:
    buffer_load_dword v6, v5, s[32:35], 0 offen sc1
    s_waitcnt vmcnt(0)
    v_cmp_ne_u32 vcc, 1, v6
    s_cmp_eq_u64 vcc, 0
    s_cbranch_scc1 PK_59
    s_sleep 6
    s_sub_u32 s38, s38, 1
    s_cmp_gt_i32 s38, 0
    s_cbranch_scc1 PL_58
PK_59:
    s_load_dwordx2 s[4:5], s[0:1], 128
    s_load_dwordx2 s[6:7], s[0:1], 144
    s_waitcnt lgkmcnt(0)
    s_add_u32 s8, s6, 50331648
    s_addc_u32 s9, s7, 0
    s_mov_b32 s10, 16777216
    s_mov_b32 s11, 0x00020000
    s_add_u32 s12, s6, 85983232
    s_addc_u32 s13, s7, 0
    s_mov_b32 s14, 4718592
    s_mov_b32 s15, 0x00020000
    s_mov_b32 s16, s4
    s_mov_b32 s17, s5
    s_mov_b32 s18, 4718592
    s_mov_b32 s19, 0x00020000
    v_lshlrev_b32 v1, 4, v0
    s_lshl_b32 s24, s40, 2
    s_add_u32 s24, s24, s20
    s_lshl_b32 s24, s24, 17
    s_mul_i32 s25, s20, 36
    s_mul_i32 s21, s41, 6
    s_add_u32 s25, s25, s21
    s_lshl_b32 s25, s25, 10
    s_lshl_b32 s26, s20, 12
    s_mul_i32 s27, s20, 6144
    s_add_u32 s27, s27, 16384
    s_and_b32 s21, s20, 1
    s_lshl_b32 s21, s21, 13
    v_add_u32 v2, s21, v1
    s_lshr_b32 s21, s20, 1
    s_mul_i32 s21, s21, 3072
    s_add_u32 s21, s21, 16384
    v_add_u32 v3, s21, v1
    s_mov_b32 s28, 0
    s_mov_b32 s29, 0
    s_lshl_b32 s21, s28, 12
    s_add_u32 s21, s21, s24
    s_add_u32 m0, s29, s26
    s_nop 0
    buffer_load_dwordx4 v1, s[8:11], s21 offen offset:0 lds
    buffer_load_dwordx4 v1, s[8:11], s21 offen offset:1024 lds
    buffer_load_dwordx4 v1, s[8:11], s21 offen offset:2048 lds
    buffer_load_dwordx4 v1, s[8:11], s21 offen offset:3072 lds
    s_mul_i32 s21, s28, 147456
    s_add_u32 s21, s21, s25
    s_add_u32 m0, s29, s27
    s_nop 0
    buffer_load_dwordx4 v1, s[12:15], s21 offen offset:0 lds
    buffer_load_dwordx4 v1, s[12:15], s21 offen offset:1024 lds
    buffer_load_dwordx4 v1, s[12:15], s21 offen offset:2048 lds
    buffer_load_dwordx4 v1, s[12:15], s21 offen offset:3072 lds
    s_add_u32 s21, s21, 4096
    s_add_u32 m0, m0, 4096
    s_nop 0
    buffer_load_dwordx4 v1, s[12:15], s21 offen offset:0 lds
    buffer_load_dwordx4 v1, s[12:15], s21 offen offset:1024 lds
    s_mov_b32 s28, 1
    s_mov_b32 s29, 40960
    s_lshl_b32 s21, s28, 12
    s_add_u32 s21, s21, s24
    s_add_u32 m0, s29, s26
    s_nop 0
    buffer_load_dwordx4 v1, s[8:11], s21 offen offset:0 lds
    buffer_load_dwordx4 v1, s[8:11], s21 offen offset:1024 lds
    buffer_load_dwordx4 v1, s[8:11], s21 offen offset:2048 lds
    buffer_load_dwordx4 v1, s[8:11], s21 offen offset:3072 lds
    s_mul_i32 s21, s28, 147456
    s_add_u32 s21, s21, s25
    s_add_u32 m0, s29, s27
    s_nop 0
    buffer_load_dwordx4 v1, s[12:15], s21 offen offset:0 lds
    buffer_load_dwordx4 v1, s[12:15], s21 offen offset:1024 lds
    buffer_load_dwordx4 v1, s[12:15], s21 offen offset:2048 lds
    buffer_load_dwordx4 v1, s[12:15], s21 offen offset:3072 lds
    s_add_u32 s21, s21, 4096
    s_add_u32 m0, m0, 4096
    s_nop 0
    buffer_load_dwordx4 v1, s[12:15], s21 offen offset:0 lds
    buffer_load_dwordx4 v1, s[12:15], s21 offen offset:1024 lds
    s_mov_b32 s28, 2
    s_mov_b32 s29, 81920
    s_lshl_b32 s21, s28, 12
    s_add_u32 s21, s21, s24
    s_add_u32 m0, s29, s26
    s_nop 0
    buffer_load_dwordx4 v1, s[8:11], s21 offen offset:0 lds
    buffer_load_dwordx4 v1, s[8:11], s21 offen offset:1024 lds
    buffer_load_dwordx4 v1, s[8:11], s21 offen offset:2048 lds
    buffer_load_dwordx4 v1, s[8:11], s21 offen offset:3072 lds
    s_mul_i32 s21, s28, 147456
    s_add_u32 s21, s21, s25
    s_add_u32 m0, s29, s27
    s_nop 0
    buffer_load_dwordx4 v1, s[12:15], s21 offen offset:0 lds
    buffer_load_dwordx4 v1, s[12:15], s21 offen offset:1024 lds
    buffer_load_dwordx4 v1, s[12:15], s21 offen offset:2048 lds
    buffer_load_dwordx4 v1, s[12:15], s21 offen offset:3072 lds
    s_add_u32 s21, s21, 4096
    s_add_u32 m0, m0, 4096
    s_nop 0
    buffer_load_dwordx4 v1, s[12:15], s21 offen offset:0 lds
    buffer_load_dwordx4 v1, s[12:15], s21 offen offset:1024 lds
    v_mov_b32 v8, 0
    v_mov_b32 v9, 0
    v_mov_b32 v10, 0
    v_mov_b32 v11, 0
    v_mov_b32 v12, 0
    v_mov_b32 v13, 0
    v_mov_b32 v14, 0
    v_mov_b32 v15, 0
    v_mov_b32 v16, 0
    v_mov_b32 v17, 0
    v_mov_b32 v18, 0
    v_mov_b32 v19, 0
    v_mov_b32 v20, 0
    v_mov_b32 v21, 0
    v_mov_b32 v22, 0
    v_mov_b32 v23, 0
    v_mov_b32 v24, 0
    v_mov_b32 v25, 0
    v_mov_b32 v26, 0
    v_mov_b32 v27, 0
    v_mov_b32 v28, 0
    v_mov_b32 v29, 0
    v_mov_b32 v30, 0
    v_mov_b32 v31, 0
    s_mov_b32 s30, 0
    s_mov_b32 s31, 0
WO_60:
    s_waitcnt vmcnt(20)
    s_barrier
    s_add_u32 s28, s30, 3
    s_and_b32 s28, s28, 31
    s_sub_u32 s29, s31, 40960
    s_cmp_eq_u32 s31, 0
    s_cselect_b32 s29, 122880, s29
    s_lshl_b32 s21, s28, 12
    s_add_u32 s21, s21, s24
    s_add_u32 m0, s29, s26
    s_nop 0
    buffer_load_dwordx4 v1, s[8:11], s21 offen offset:0 lds
    buffer_load_dwordx4 v1, s[8:11], s21 offen offset:1024 lds
    buffer_load_dwordx4 v1, s[8:11], s21 offen offset:2048 lds
    buffer_load_dwordx4 v1, s[8:11], s21 offen offset:3072 lds
    s_mul_i32 s21, s28, 147456
    s_add_u32 s21, s21, s25
    s_add_u32 m0, s29, s27
    s_nop 0
    buffer_load_dwordx4 v1, s[12:15], s21 offen offset:0 lds
    buffer_load_dwordx4 v1, s[12:15], s21 offen offset:1024 lds
    buffer_load_dwordx4 v1, s[12:15], s21 offen offset:2048 lds
    buffer_load_dwordx4 v1, s[12:15], s21 offen offset:3072 lds
    s_add_u32 s21, s21, 4096
    s_add_u32 m0, m0, 4096
    s_nop 0
    buffer_load_dwordx4 v1, s[12:15], s21 offen offset:0 lds
    buffer_load_dwordx4 v1, s[12:15], s21 offen offset:1024 lds
    v_add_u32 v4, s31, v2
    v_add_u32 v5, s31, v3
    ds_read_b128 v[32:35], v4 offset:0
    ds_read_b128 v[36:39], v4 offset:4096
    ds_read_b128 v[40:43], v5 offset:0
    ds_read_b128 v[44:47], v5 offset:1024
    ds_read_b128 v[48:51], v5 offset:2048
    ds_read_b128 v[52:55], v4 offset:1024
    ds_read_b128 v[56:59], v4 offset:5120
    ds_read_b128 v[60:63], v5 offset:6144
    ds_read_b128 v[64:67], v5 offset:7168
    ds_read_b128 v[68:71], v5 offset:8192
    s_waitcnt lgkmcnt(5)
    v_mfma_f32_16x16x32_bf16 v[8:11], v[40:43], v[32:35], v[8:11]
    v_mfma_f32_16x16x32_bf16 v[12:15], v[44:47], v[32:35], v[12:15]
    v_mfma_f32_16x16x32_bf16 v[16:19], v[48:51], v[32:35], v[16:19]
    v_mfma_f32_16x16x32_bf16 v[20:23], v[40:43], v[36:39], v[20:23]
    v_mfma_f32_16x16x32_bf16 v[24:27], v[44:47], v[36:39], v[24:27]
    v_mfma_f32_16x16x32_bf16 v[28:31], v[48:51], v[36:39], v[28:31]
    ds_read_b128 v[32:35], v4 offset:2048
    ds_read_b128 v[36:39], v4 offset:6144
    ds_read_b128 v[40:43], v5 offset:12288
    ds_read_b128 v[44:47], v5 offset:13312
    ds_read_b128 v[48:51], v5 offset:14336
    s_waitcnt lgkmcnt(5)
    v_mfma_f32_16x16x32_bf16 v[8:11], v[60:63], v[52:55], v[8:11]
    v_mfma_f32_16x16x32_bf16 v[12:15], v[64:67], v[52:55], v[12:15]
    v_mfma_f32_16x16x32_bf16 v[16:19], v[68:71], v[52:55], v[16:19]
    v_mfma_f32_16x16x32_bf16 v[20:23], v[60:63], v[56:59], v[20:23]
    v_mfma_f32_16x16x32_bf16 v[24:27], v[64:67], v[56:59], v[24:27]
    v_mfma_f32_16x16x32_bf16 v[28:31], v[68:71], v[56:59], v[28:31]
    ds_read_b128 v[52:55], v4 offset:3072
    ds_read_b128 v[56:59], v4 offset:7168
    ds_read_b128 v[60:63], v5 offset:18432
    ds_read_b128 v[64:67], v5 offset:19456
    ds_read_b128 v[68:71], v5 offset:20480
    s_waitcnt lgkmcnt(5)
    v_mfma_f32_16x16x32_bf16 v[8:11], v[40:43], v[32:35], v[8:11]
    v_mfma_f32_16x16x32_bf16 v[12:15], v[44:47], v[32:35], v[12:15]
    v_mfma_f32_16x16x32_bf16 v[16:19], v[48:51], v[32:35], v[16:19]
    v_mfma_f32_16x16x32_bf16 v[20:23], v[40:43], v[36:39], v[20:23]
    v_mfma_f32_16x16x32_bf16 v[24:27], v[44:47], v[36:39], v[24:27]
    v_mfma_f32_16x16x32_bf16 v[28:31], v[48:51], v[36:39], v[28:31]
    s_waitcnt lgkmcnt(0)
    v_mfma_f32_16x16x32_bf16 v[8:11], v[60:63], v[52:55], v[8:11]
    v_mfma_f32_16x16x32_bf16 v[12:15], v[64:67], v[52:55], v[12:15]
    v_mfma_f32_16x16x32_bf16 v[16:19], v[68:71], v[52:55], v[16:19]
    v_mfma_f32_16x16x32_bf16 v[20:23], v[60:63], v[56:59], v[20:23]
    v_mfma_f32_16x16x32_bf16 v[24:27], v[64:67], v[56:59], v[24:27]
    v_mfma_f32_16x16x32_bf16 v[28:31], v[68:71], v[56:59], v[28:31]
    s_add_u32 s31, s31, 40960
    s_cmp_eq_u32 s31, 163840
    s_cselect_b32 s31, 0, s31
    s_add_u32 s30, s30, 1
    s_cmp_lt_u32 s30, 32
    s_cbranch_scc1 WO_60
    v_and_b32 v4, 15, v0
    v_mul_u32_u24 v4, 2304, v4
    v_lshrrev_b32 v5, 4, v0
    v_lshl_add_u32 v4, v5, 3, v4
    s_lshl_b32 s21, s40, 2
    s_and_b32 s22, s20, 1
    s_lshl_b32 s22, s22, 1
    s_add_u32 s21, s21, s22
    s_mul_i32 s21, s21, 36864
    s_mul_i32 s22, s41, 192
    s_add_u32 s21, s21, s22
    s_lshr_b32 s22, s20, 1
    s_mul_i32 s22, s22, 96
    s_add_u32 s21, s21, s22
    s_add_u32 s22, s21, 36864
    s_nop 5
    v_cvt_pk_bf16_f32 v8, v8, v9
    v_cvt_pk_bf16_f32 v9, v10, v11
    buffer_store_dwordx2 v[8:9], v4, s[16:19], s21 offen offset:0
    v_cvt_pk_bf16_f32 v12, v12, v13
    v_cvt_pk_bf16_f32 v13, v14, v15
    buffer_store_dwordx2 v[12:13], v4, s[16:19], s21 offen offset:32
    v_cvt_pk_bf16_f32 v16, v16, v17
    v_cvt_pk_bf16_f32 v17, v18, v19
    buffer_store_dwordx2 v[16:17], v4, s[16:19], s21 offen offset:64
    v_cvt_pk_bf16_f32 v20, v20, v21
    v_cvt_pk_bf16_f32 v21, v22, v23
    buffer_store_dwordx2 v[20:21], v4, s[16:19], s22 offen offset:0
    v_cvt_pk_bf16_f32 v24, v24, v25
    v_cvt_pk_bf16_f32 v25, v26, v27
    buffer_store_dwordx2 v[24:25], v4, s[16:19], s22 offen offset:32
    v_cvt_pk_bf16_f32 v28, v28, v29
    v_cvt_pk_bf16_f32 v29, v30, v31
    buffer_store_dwordx2 v[28:29], v4, s[16:19], s22 offen offset:64
    s_waitcnt vmcnt(0)
    s_barrier
    s_branch M_WORK
M_FINE:
    s_lshl_b32 s42, s40, 3
    v_and_b32 v5, 7, v0
    v_add_u32 v5, s42, v5
    v_lshlrev_b32 v5, 2, v5
    v_add_u32 v5, 16384, v5
    s_mov_b32 s38, 40000
PL_61:
    buffer_load_dword v6, v5, s[32:35], 0 offen sc1
    s_waitcnt vmcnt(0)
    v_cmp_ne_u32 vcc, 1, v6
    s_cmp_eq_u64 vcc, 0
    s_cbranch_scc1 PK_62
    s_sleep 6
    s_sub_u32 s38, s38, 1
    s_cmp_gt_i32 s38, 0
    s_cbranch_scc1 PL_61
PK_62:
    s_sub_u32 s41, s41, 8
    s_lshl_b32 s40, s40, 1
    s_cmp_ge_u32 s41, 36
    s_cselect_b32 s21, 1, 0
    s_add_u32 s40, s40, s21
    s_mul_i32 s21, s21, 36
    s_sub_u32 s41, s41, s21
    s_load_dwordx2 s[4:5], s[0:1], 128
    s_waitcnt lgkmcnt(0)
    s_add_u32 s8, s6, 50331648
    s_addc_u32 s9, s7, 0
    s_mov_b32 s10, 16777216
    s_mov_b32 s11, 0x00020000
    s_add_u32 s12, s6, 85983232
    s_addc_u32 s13, s7, 0
    s_mov_b32 s14, 4718592
    s_mov_b32 s15, 0x00020000
    s_mov_b32 s16, s4
    s_mov_b32 s17, s5
    s_mov_b32 s18, 4718592
    s_mov_b32 s19, 0x00020000
    v_lshlrev_b32 v1, 4, v0
    s_lshl_b32 s24, s40, 17
    s_lshl_b32 s21, s20, 15
    s_add_u32 s24, s24, s21
    s_mul_i32 s25, s20, 1179648
    s_lshl_b32 s21, s41, 10
    s_add_u32 s25, s25, s21
    s_add_u32 s21, s24, 0
    buffer_load_dwordx4 v[64:67], v1, s[8:11], s21 offen offset:0 sc1
    buffer_load_dwordx4 v[68:71], v1, s[8:11], s21 offen offset:1024 sc1
    buffer_load_dwordx4 v[72:75], v1, s[8:11], s21 offen offset:2048 sc1
    buffer_load_dwordx4 v[76:79], v1, s[8:11], s21 offen offset:3072 sc1
    s_add_u32 s22, s25, 0
    buffer_load_dwordx4 v[80:83], v1, s[12:15], s22 offen
    s_add_u32 s22, s25, 36864
    buffer_load_dwordx4 v[84:87], v1, s[12:15], s22 offen
    s_add_u32 s22, s25, 73728
    buffer_load_dwordx4 v[88:91], v1, s[12:15], s22 offen
    s_add_u32 s22, s25, 110592
    buffer_load_dwordx4 v[92:95], v1, s[12:15], s22 offen
    s_add_u32 s21, s24, 4096
    buffer_load_dwordx4 v[96:99], v1, s[8:11], s21 offen offset:0 sc1
    buffer_load_dwordx4 v[100:103], v1, s[8:11], s21 offen offset:1024 sc1
    buffer_load_dwordx4 v[104:107], v1, s[8:11], s21 offen offset:2048 sc1
    buffer_load_dwordx4 v[108:111], v1, s[8:11], s21 offen offset:3072 sc1
    s_add_u32 s22, s25, 147456
    buffer_load_dwordx4 v[112:115], v1, s[12:15], s22 offen
    s_add_u32 s22, s25, 184320
    buffer_load_dwordx4 v[116:119], v1, s[12:15], s22 offen
    s_add_u32 s22, s25, 221184
    buffer_load_dwordx4 v[120:123], v1, s[12:15], s22 offen
    s_add_u32 s22, s25, 258048
    buffer_load_dwordx4 v[124:127], v1, s[12:15], s22 offen
    s_add_u32 s21, s24, 8192
    buffer_load_dwordx4 v[128:131], v1, s[8:11], s21 offen offset:0 sc1
    buffer_load_dwordx4 v[132:135], v1, s[8:11], s21 offen offset:1024 sc1
    buffer_load_dwordx4 v[136:139], v1, s[8:11], s21 offen offset:2048 sc1
    buffer_load_dwordx4 v[140:143], v1, s[8:11], s21 offen offset:3072 sc1
    s_add_u32 s22, s25, 294912
    buffer_load_dwordx4 v[144:147], v1, s[12:15], s22 offen
    s_add_u32 s22, s25, 331776
    buffer_load_dwordx4 v[148:151], v1, s[12:15], s22 offen
    s_add_u32 s22, s25, 368640
    buffer_load_dwordx4 v[152:155], v1, s[12:15], s22 offen
    s_add_u32 s22, s25, 405504
    buffer_load_dwordx4 v[156:159], v1, s[12:15], s22 offen
    s_add_u32 s21, s24, 12288
    buffer_load_dwordx4 v[160:163], v1, s[8:11], s21 offen offset:0 sc1
    buffer_load_dwordx4 v[164:167], v1, s[8:11], s21 offen offset:1024 sc1
    buffer_load_dwordx4 v[168:171], v1, s[8:11], s21 offen offset:2048 sc1
    buffer_load_dwordx4 v[172:175], v1, s[8:11], s21 offen offset:3072 sc1
    s_add_u32 s22, s25, 442368
    buffer_load_dwordx4 v[176:179], v1, s[12:15], s22 offen
    s_add_u32 s22, s25, 479232
    buffer_load_dwordx4 v[180:183], v1, s[12:15], s22 offen
    s_add_u32 s22, s25, 516096
    buffer_load_dwordx4 v[184:187], v1, s[12:15], s22 offen
    s_add_u32 s22, s25, 552960
    buffer_load_dwordx4 v[188:191], v1, s[12:15], s22 offen
    s_add_u32 s21, s24, 16384
    buffer_load_dwordx4 v[192:195], v1, s[8:11], s21 offen offset:0 sc1
    buffer_load_dwordx4 v[196:199], v1, s[8:11], s21 offen offset:1024 sc1
    buffer_load_dwordx4 v[200:203], v1, s[8:11], s21 offen offset:2048 sc1
    buffer_load_dwordx4 v[204:207], v1, s[8:11], s21 offen offset:3072 sc1
    s_add_u32 s22, s25, 589824
    buffer_load_dwordx4 v[208:211], v1, s[12:15], s22 offen
    s_add_u32 s22, s25, 626688
    buffer_load_dwordx4 v[212:215], v1, s[12:15], s22 offen
    s_add_u32 s22, s25, 663552
    buffer_load_dwordx4 v[216:219], v1, s[12:15], s22 offen
    s_add_u32 s22, s25, 700416
    buffer_load_dwordx4 v[220:223], v1, s[12:15], s22 offen
    s_add_u32 s21, s24, 20480
    buffer_load_dwordx4 v[224:227], v1, s[8:11], s21 offen offset:0 sc1
    buffer_load_dwordx4 v[228:231], v1, s[8:11], s21 offen offset:1024 sc1
    buffer_load_dwordx4 v[232:235], v1, s[8:11], s21 offen offset:2048 sc1
    buffer_load_dwordx4 v[236:239], v1, s[8:11], s21 offen offset:3072 sc1
    s_add_u32 s22, s25, 737280
    buffer_load_dwordx4 v[240:243], v1, s[12:15], s22 offen
    s_add_u32 s22, s25, 774144
    buffer_load_dwordx4 v[244:247], v1, s[12:15], s22 offen
    s_add_u32 s22, s25, 811008
    buffer_load_dwordx4 v[248:251], v1, s[12:15], s22 offen
    s_add_u32 s22, s25, 847872
    buffer_load_dwordx4 v[252:255], v1, s[12:15], s22 offen
    s_waitcnt vmcnt(32)
    v_mfma_f32_16x16x32_bf16 v[8:11], v[80:83], v[64:67], 0
    v_mfma_f32_16x16x32_bf16 v[12:15], v[84:87], v[68:71], 0
    v_mfma_f32_16x16x32_bf16 v[8:11], v[88:91], v[72:75], v[8:11]
    v_mfma_f32_16x16x32_bf16 v[12:15], v[92:95], v[76:79], v[12:15]
    v_mfma_f32_16x16x32_bf16 v[8:11], v[112:115], v[96:99], v[8:11]
    v_mfma_f32_16x16x32_bf16 v[12:15], v[116:119], v[100:103], v[12:15]
    v_mfma_f32_16x16x32_bf16 v[8:11], v[120:123], v[104:107], v[8:11]
    v_mfma_f32_16x16x32_bf16 v[12:15], v[124:127], v[108:111], v[12:15]
    s_nop 3
    s_add_u32 s21, s24, 24576
    buffer_load_dwordx4 v[64:67], v1, s[8:11], s21 offen offset:0 sc1
    buffer_load_dwordx4 v[68:71], v1, s[8:11], s21 offen offset:1024 sc1
    buffer_load_dwordx4 v[72:75], v1, s[8:11], s21 offen offset:2048 sc1
    buffer_load_dwordx4 v[76:79], v1, s[8:11], s21 offen offset:3072 sc1
    s_add_u32 s22, s25, 884736
    buffer_load_dwordx4 v[80:83], v1, s[12:15], s22 offen
    s_add_u32 s22, s25, 921600
    buffer_load_dwordx4 v[84:87], v1, s[12:15], s22 offen
    s_add_u32 s22, s25, 958464
    buffer_load_dwordx4 v[88:91], v1, s[12:15], s22 offen
    s_add_u32 s22, s25, 995328
    buffer_load_dwordx4 v[92:95], v1, s[12:15], s22 offen
    s_add_u32 s21, s24, 28672
    buffer_load_dwordx4 v[96:99], v1, s[8:11], s21 offen offset:0 sc1
    buffer_load_dwordx4 v[100:103], v1, s[8:11], s21 offen offset:1024 sc1
    buffer_load_dwordx4 v[104:107], v1, s[8:11], s21 offen offset:2048 sc1
    buffer_load_dwordx4 v[108:111], v1, s[8:11], s21 offen offset:3072 sc1
    s_add_u32 s22, s25, 1032192
    buffer_load_dwordx4 v[112:115], v1, s[12:15], s22 offen
    s_add_u32 s22, s25, 1069056
    buffer_load_dwordx4 v[116:119], v1, s[12:15], s22 offen
    s_add_u32 s22, s25, 1105920
    buffer_load_dwordx4 v[120:123], v1, s[12:15], s22 offen
    s_add_u32 s22, s25, 1142784
    buffer_load_dwordx4 v[124:127], v1, s[12:15], s22 offen
    s_waitcnt vmcnt(32)
    v_mfma_f32_16x16x32_bf16 v[8:11], v[144:147], v[128:131], v[8:11]
    v_mfma_f32_16x16x32_bf16 v[12:15], v[148:151], v[132:135], v[12:15]
    v_mfma_f32_16x16x32_bf16 v[8:11], v[152:155], v[136:139], v[8:11]
    v_mfma_f32_16x16x32_bf16 v[12:15], v[156:159], v[140:143], v[12:15]
    v_mfma_f32_16x16x32_bf16 v[8:11], v[176:179], v[160:163], v[8:11]
    v_mfma_f32_16x16x32_bf16 v[12:15], v[180:183], v[164:167], v[12:15]
    v_mfma_f32_16x16x32_bf16 v[8:11], v[184:187], v[168:171], v[8:11]
    v_mfma_f32_16x16x32_bf16 v[12:15], v[188:191], v[172:175], v[12:15]
    s_waitcnt vmcnt(16)
    v_mfma_f32_16x16x32_bf16 v[8:11], v[208:211], v[192:195], v[8:11]
    v_mfma_f32_16x16x32_bf16 v[12:15], v[212:215], v[196:199], v[12:15]
    v_mfma_f32_16x16x32_bf16 v[8:11], v[216:219], v[200:203], v[8:11]
    v_mfma_f32_16x16x32_bf16 v[12:15], v[220:223], v[204:207], v[12:15]
    v_mfma_f32_16x16x32_bf16 v[8:11], v[240:243], v[224:227], v[8:11]
    v_mfma_f32_16x16x32_bf16 v[12:15], v[244:247], v[228:231], v[12:15]
    v_mfma_f32_16x16x32_bf16 v[8:11], v[248:251], v[232:235], v[8:11]
    v_mfma_f32_16x16x32_bf16 v[12:15], v[252:255], v[236:239], v[12:15]
    s_waitcnt vmcnt(0)
    v_mfma_f32_16x16x32_bf16 v[8:11], v[80:83], v[64:67], v[8:11]
    v_mfma_f32_16x16x32_bf16 v[12:15], v[84:87], v[68:71], v[12:15]
    v_mfma_f32_16x16x32_bf16 v[8:11], v[88:91], v[72:75], v[8:11]
    v_mfma_f32_16x16x32_bf16 v[12:15], v[92:95], v[76:79], v[12:15]
    v_mfma_f32_16x16x32_bf16 v[8:11], v[112:115], v[96:99], v[8:11]
    v_mfma_f32_16x16x32_bf16 v[12:15], v[116:119], v[100:103], v[12:15]
    v_mfma_f32_16x16x32_bf16 v[8:11], v[120:123], v[104:107], v[8:11]
    v_mfma_f32_16x16x32_bf16 v[12:15], v[124:127], v[108:111], v[12:15]
    s_nop 7
    v_add_f32 v8, v8, v12
    v_add_f32 v9, v9, v13
    v_add_f32 v10, v10, v14
    v_add_f32 v11, v11, v15
    s_lshl_b32 s21, s20, 10
    v_add_u32 v2, s21, v1
    ds_write_b128 v2, v[8:11]
    s_waitcnt lgkmcnt(0)
    s_barrier
    s_cmp_lg_u32 s20, 0
    s_cbranch_scc1 FN_63
    ds_read_b128 v[12:15], v1 offset:1024
    ds_read_b128 v[16:19], v1 offset:2048
    ds_read_b128 v[20:23], v1 offset:3072
    v_and_b32 v4, 15, v0
    v_mul_u32_u24 v4, 2304, v4
    v_lshrrev_b32 v5, 4, v0
    v_lshl_add_u32 v4, v5, 3, v4
    s_mul_i32 s21, s40, 36864
    s_lshl_b32 s22, s41, 5
    s_add_u32 s21, s21, s22
    s_waitcnt lgkmcnt(0)
    v_add_f32 v8, v8, v12
    v_add_f32 v16, v16, v20
    v_add_f32 v9, v9, v13
    v_add_f32 v17, v17, v21
    v_add_f32 v10, v10, v14
    v_add_f32 v18, v18, v22
    v_add_f32 v11, v11, v15
    v_add_f32 v19, v19, v23
    v_add_f32 v8, v8, v16
    v_add_f32 v9, v9, v17
    v_add_f32 v10, v10, v18
    v_add_f32 v11, v11, v19
    v_cvt_pk_bf16_f32 v8, v8, v9
    v_cvt_pk_bf16_f32 v9, v10, v11
    buffer_store_dwordx2 v[8:9], v4, s[16:19], s21 offen
    s_waitcnt vmcnt(0)
FN_63:
    s_branch M_WORK
M_END:
M_EXIT:
    s_endpgm
.section .rodata,"a"
.p2align 6
.amdhsa_kernel main_kernel
  .amdhsa_next_free_vgpr 512
  .amdhsa_next_free_sgpr 102
  .amdhsa_accum_offset 256
  .amdhsa_group_segment_fixed_size 0
  .amdhsa_kernarg_size 152
  .amdhsa_user_sgpr_count 2
  .amdhsa_user_sgpr_kernarg_segment_ptr 1
  .amdhsa_system_sgpr_workgroup_id_x 1
.end_amdhsa_kernel
```
